```python
import torch

def _softmax(x, axis=-1):
    return torch.softmax(x, dim=axis)
def _gelu(x):
    return torch.nn.functional.gelu(x, approximate="tanh")
def _silu(x):
    return torch.nn.functional.silu(x)
def _sigmoid(x):
    return torch.sigmoid(x)
def _layernorm(x, axis=-1, eps=1e-5):
    m = x.mean(dim=axis, keepdim=True)
    v = x.var(dim=axis, keepdim=True, unbiased=False)
    return (x - m) / torch.sqrt(v + eps)
def _scatter_add(tgt, idx, src, axis=0):
    return tgt.clone().index_add_(axis, idx, src)
def _segment_sum(src, seg, n):
    out = torch.zeros((n,) + src.shape[1:], dtype=src.dtype)
    return out.index_add_(0, seg, src)
def _pad(x, pw):
    flat = tuple(v for pair in reversed(pw) for v in pair)
    return torch.nn.functional.pad(x, flat)

kernel_name = 'recurrent_scan__gqa_block_cached__swiglu_ffn__decode'

def setup_inputs():

    _w = (lambda a: (lambda t: t.to(torch.bfloat16) if t.is_floating_point() else t)(torch.as_tensor(a)))
    def _A_setup():
        B, Sq, D = 1, 1, 576
        Hq, Hkv, Sk, Dh = 32, 16, 8192, 128
        assert Hq % Hkv == 0, (Hq, Hkv)
        return {
            "x": _w((lambda *s: torch.randn(*s, dtype=torch.bfloat16) * 0.05)(B, Sq, D)),
            "k_cache": _w((lambda *s: torch.randn(*s, dtype=torch.bfloat16) * 1.6)(B, Hkv, Sk, Dh)),
            "v_cache": _w((lambda *s: torch.randn(*s, dtype=torch.bfloat16) * 0.2)(B, Hkv, Sk, Dh)),
            "wq": _w((lambda *s: torch.randn(*s, dtype=torch.bfloat16) * 1.6)(D, Hq * Dh) * (D ** -0.5)),
            "wo": _w((lambda *s: torch.randn(*s, dtype=torch.bfloat16) * 0.2)(Hq * Dh, D) * ((Hq * Dh) ** -0.5)),
        }
    _A_in = _A_setup()

    def _B_setup():
        B, S, D, F = 1, 1, 576, 4608
        return {
            "x": _w((lambda *s: torch.randn(*s, dtype=torch.bfloat16) * 0.05)(B, S, D)),
            "w_gate": _w((lambda *s: torch.randn(*s, dtype=torch.bfloat16) * 0.1)(D, F)),
            "w_up": _w((lambda *s: torch.randn(*s, dtype=torch.bfloat16) * 0.1)(D, F)),
            "w_down": _w((lambda *s: torch.randn(*s, dtype=torch.bfloat16) * 0.1)(F, D)),
        }
    _B_in = _B_setup()

    return {
        "A_x": _A_in["x"],
        "A_k_cache": _A_in["k_cache"],
        "A_v_cache": _A_in["v_cache"],
        "A_wq": _A_in["wq"],
        "A_wo": _A_in["wo"],
        "B_x": _B_in["x"],
        "B_w_gate": _B_in["w_gate"],
        "B_w_up": _B_in["w_up"],
        "B_w_down": _B_in["w_down"],
    }

def reference(A_x, A_k_cache, A_v_cache, A_wq, A_wo, B_x, B_w_gate, B_w_up, B_w_down):
    def _A_ref(x, k_cache, v_cache, wq, wo):
        B, Sq, D = x.shape
        Hq, Dh = 32, 128
        Hkv = k_cache.shape[1]
        rep = Hq // Hkv
        q = (lambda x, *d: x.permute(*d))((x @ wq).reshape(B, Sq, Hq, Dh), 0, 2, 1, 3)
        k = (lambda x, n, axis: torch.repeat_interleave(x, n, dim=axis))(k_cache, rep, axis=1)
        v = (lambda x, n, axis: torch.repeat_interleave(x, n, dim=axis))(v_cache, rep, axis=1)
        scores = torch.einsum("bhqd,bhkd->bhqk", q, k) * (Dh ** -0.5)
        p = _softmax(scores, axis=-1)
        o = torch.einsum("bhqk,bhkd->bhqd", p, v)
        return (lambda x, *d: x.permute(*d))(o, 0, 2, 1, 3).reshape(B, Sq, Hq * Dh) @ wo

    def _B_ref(x, w_gate, w_up, w_down):
        g = _silu(x @ w_gate)
        u = x @ w_up
        return (g * u) @ w_down

    x = A_x
    xn = _layernorm(x, axis=-1)
    s = _A_ref(xn, A_k_cache, A_v_cache, A_wq, A_wo)
    g = _silu(_B_ref(xn, B_w_gate, B_w_up, B_w_down))
    return x + s * g
```

```asm
; @launch grid=(256,1,1) block=(768,1,1) lds=11648
.amdgcn_target "amdgcn-amd-amdhsa--gfx950"
.text
.globl recurrent_scan__gqa_block_cached__swiglu_ffn__decode_kernel
.p2align 8
.type recurrent_scan__gqa_block_cached__swiglu_ffn__decode_kernel,@function
recurrent_scan__gqa_block_cached__swiglu_ffn__decode_kernel:
    s_cmp_ge_u32 s2, 256
    s_cbranch_scc1 L_exit
    s_load_dwordx16 s[4:19], s[0:1], 0
    s_load_dwordx8 s[20:27], s[0:1], 64
    v_lshrrev_b32 v1, 6, v0
    v_and_b32 v0, 63, v0
    s_and_b32 s28, s2, 7
    v_readfirstlane_b32 s3, v1
    s_lshl_b32 s28, s28, 5
    s_lshr_b32 s29, s2, 3
    s_add_u32 s28, s28, s29
    s_bfe_u32 s29, s28, 0x20002
    s_xor_b32 s28, s28, s29
    s_and_b32 s31, s28, 3
    s_mov_b32 s39, 0x20000
    s_mov_b32 s43, s39
    s_mov_b32 s47, s39
    s_mov_b32 s55, s39
    s_brev_b32 s54, 8
    v_lshlrev_b32 v2, 4, v0
    s_cmp_ge_u32 s3, 4
    s_cbranch_scc1 L_KV
    s_setprio 3
    v_lshrrev_b32 v13, 4, v0
    v_lshrrev_b32 v14, 1, v0
    v_and_or_b32 v13, v14, 4, v13
    v_and_b32 v14, 7, v0
    v_lshlrev_b32 v1, 1, v0
    v_mov_b32 v24, 0
    s_movk_i32 s38, 1152
    s_cmp_lg_u32 s3, 0
    s_cbranch_scc1 L_Tpar
    s_movk_i32 s61, 8192
    s_mov_b32 s42, 4718592
    s_mul_i32 s60, s31, 1179648
    s_lshr_b32 s33, s28, 2
    s_lshl_b32 s34, s33, 7
    s_add_u32 s60, s60, s34
    v_mul_u32_u24 v3, 147456, v13
    s_mov_b32 s30, s31
    ds_write_b32 v24, v24 offset:2816
    ds_write_b16 v1, v24 offset:11264
    s_waitcnt lgkmcnt(0)
    s_mov_b64 s[40:41], s[10:11]
    s_mov_b64 s[36:37], s[4:5]
    v_lshl_add_u32 v3, v14, 4, v3
    buffer_load_dwordx4 v[8:11], v2, s[36:39], 0 offen
    buffer_load_short_d16_hi v24, v1, s[36:39], 0 offen offset:1024
    buffer_load_dwordx4 v[64:67], v3, s[40:43], s60 offen nt
    s_add_u32 s60, s60, s61
    buffer_load_dwordx4 v[68:71], v3, s[40:43], s60 offen nt
    s_add_u32 s60, s60, s61
    buffer_load_dwordx4 v[72:75], v3, s[40:43], s60 offen nt
    s_add_u32 s60, s60, s61
    buffer_load_dwordx4 v[76:79], v3, s[40:43], s60 offen nt
    s_add_u32 s60, s60, s61
    buffer_load_dwordx4 v[80:83], v3, s[40:43], s60 offen nt
    s_add_u32 s60, s60, s61
    buffer_load_dwordx4 v[84:87], v3, s[40:43], s60 offen nt
    s_add_u32 s60, s60, s61
    buffer_load_dwordx4 v[88:91], v3, s[40:43], s60 offen nt
    s_add_u32 s60, s60, s61
    buffer_load_dwordx4 v[92:95], v3, s[40:43], s60 offen nt
    s_add_u32 s60, s60, s61
    buffer_load_dwordx4 v[96:99], v3, s[40:43], s60 offen nt
    s_add_u32 s60, s60, s61
    buffer_load_dwordx4 v[100:103], v3, s[40:43], s60 offen nt
    s_add_u32 s60, s60, s61
    buffer_load_dwordx4 v[104:107], v3, s[40:43], s60 offen nt
    s_add_u32 s60, s60, s61
    buffer_load_dwordx4 v[108:111], v3, s[40:43], s60 offen nt
    s_add_u32 s60, s60, s61
    buffer_load_dwordx4 v[112:115], v3, s[40:43], s60 offen nt
    s_add_u32 s60, s60, s61
    buffer_load_dwordx4 v[116:119], v3, s[40:43], s60 offen nt
    s_add_u32 s60, s60, s61
    buffer_load_dwordx4 v[120:123], v3, s[40:43], s60 offen nt
    s_add_u32 s60, s60, s61
    buffer_load_dwordx4 v[124:127], v3, s[40:43], s60 offen nt
    s_add_u32 s60, s60, s61
    buffer_load_dwordx4 v[128:131], v3, s[40:43], s60 offen nt
    s_add_u32 s60, s60, s61
    buffer_load_dwordx4 v[132:135], v3, s[40:43], s60 offen nt
    s_barrier
    s_lshr_b32 s66, s28, 4
    s_lshl_b32 s66, s66, 13
    s_add_u32 s67, s66, 131072
    s_lshl_b32 s66, s31, 2
    s_and_b32 s33, s33, 3
    s_add_u32 s66, s66, s33
    s_lshl_b32 s66, s66, 9
    s_add_u32 s66, s66, s67
    s_getreg_b32 s97, hwreg(HW_REG_XCC_ID, 0, 4)
    s_add_u32 s97, s97, 1
L_P1b:
    s_mov_b64 s[52:53], s[26:27]
    s_load_dword s32, s[26:27], 0
    s_mov_b32 s96, 100000
    v_and_b32 v12, 1, v0
    v_lshlrev_b32 v12, 4, v12
    v_mov_b32 v15, 0xffff
    v_lshlrev_b32 v12, v12, v15
    v_bfe_u32 v15, v0, 1, 2
    v_cmp_eq_u32 s[68:69], 0, v15
    v_cmp_eq_u32 s[70:71], 1, v15
    v_cmp_eq_u32 s[72:73], 2, v15
    v_cmp_eq_u32 s[74:75], 3, v15
    v_cndmask_b32 v4, 0, v12, s[68:69]
    v_cndmask_b32 v5, 0, v12, s[70:71]
    v_cndmask_b32 v6, 0, v12, s[72:73]
    v_cndmask_b32 v7, 0, v12, s[74:75]
    v_and_b32 v12, 24, v0
    v_lshlrev_b32 v12, 4, v12
    v_lshl_or_b32 v12, v14, 3, v12
    v_and_b32 v15, 32, v0
    v_lshl_or_b32 v12, v15, 1, v12
    s_mul_i32 s30, s30, 576
    v_mul_u32_u24 v15, 72, v13
    v_add_u32 v15, s30, v15
    v_lshlrev_b32 v1, 5, v0
    v_lshlrev_b32 v25, 2, v0
    s_cmp_lg_u32 s3, 0
    s_cbranch_scc0 L_P1c
    s_waitcnt vmcnt(5)
L_P1c:
    s_waitcnt vmcnt(18)
    v_lshlrev_b32 v16, 16, v8
    v_and_b32 v17, 0xffff0000, v8
    v_lshlrev_b32 v18, 16, v9
    v_and_b32 v19, 0xffff0000, v9
    v_lshlrev_b32 v20, 16, v10
    v_and_b32 v21, 0xffff0000, v10
    v_lshlrev_b32 v22, 16, v11
    v_and_b32 v23, 0xffff0000, v11
    v_add_f32 v8, v16, v17
    v_add_f32 v9, v18, v19
    v_add_f32 v10, v20, v21
    v_add_f32 v11, v22, v23
    v_add_f32 v8, v8, v9
    v_add_f32 v10, v10, v11
    v_add_f32 v8, v8, v24
    v_add_f32 v8, v8, v10
    s_nop 1
    v_add_f32_dpp v8, v8, v8 row_ror:8 row_mask:0xf bank_mask:0xf
    s_nop 1
    v_add_f32_dpp v8, v8, v8 row_ror:4 row_mask:0xf bank_mask:0xf
    s_nop 1
    v_add_f32_dpp v8, v8, v8 row_ror:2 row_mask:0xf bank_mask:0xf
    s_nop 1
    v_add_f32_dpp v8, v8, v8 row_ror:1 row_mask:0xf bank_mask:0xf
    v_mov_b32 v9, v8
    s_nop 1
    v_permlane16_swap_b32 v8, v9
    v_add_f32 v8, v8, v9
    v_mov_b32 v9, v8
    s_nop 1
    v_permlane32_swap_b32 v8, v9
    v_add_f32 v8, v8, v9
    v_mul_f32 v8, 0x3ae38e39, v8
    v_sub_f32 v10, v16, v8
    v_mul_f32 v9, v10, v10
    v_sub_f32 v10, v17, v8
    v_fmac_f32 v9, v10, v10
    v_sub_f32 v10, v18, v8
    v_fmac_f32 v9, v10, v10
    v_sub_f32 v10, v19, v8
    v_fmac_f32 v9, v10, v10
    v_sub_f32 v10, v20, v8
    v_fmac_f32 v9, v10, v10
    v_sub_f32 v10, v21, v8
    v_fmac_f32 v9, v10, v10
    v_sub_f32 v10, v22, v8
    v_fmac_f32 v9, v10, v10
    v_sub_f32 v10, v23, v8
    v_fmac_f32 v9, v10, v10
    v_sub_f32 v10, v24, v8
    v_fmac_f32 v9, v10, v10
    s_nop 1
    v_add_f32_dpp v9, v9, v9 row_ror:8 row_mask:0xf bank_mask:0xf
    s_nop 1
    v_add_f32_dpp v9, v9, v9 row_ror:4 row_mask:0xf bank_mask:0xf
    s_nop 1
    v_add_f32_dpp v9, v9, v9 row_ror:2 row_mask:0xf bank_mask:0xf
    s_nop 1
    v_add_f32_dpp v9, v9, v9 row_ror:1 row_mask:0xf bank_mask:0xf
    v_mov_b32 v10, v9
    s_nop 1
    v_permlane16_swap_b32 v9, v10
    v_add_f32 v9, v9, v10
    v_mov_b32 v10, v9
    s_nop 1
    v_permlane32_swap_b32 v9, v10
    v_add_f32 v9, v9, v10
    v_mul_f32 v9, 0x3ae38e39, v9
    v_cvt_pk_bf16_f32 v8, 0, v8
    v_cvt_pk_bf16_f32 v9, 0, v9
    v_add_f32 v9, 0x3727c5ac, v9
    v_cvt_pk_bf16_f32 v9, 0, v9
    v_sqrt_f32 v9, v9
    s_nop 0
    v_cvt_pk_bf16_f32 v9, 0, v9
    v_rcp_f32 v10, v9
    v_sub_f32 v16, v16, v8
    v_sub_f32 v17, v17, v8
    v_sub_f32 v18, v18, v8
    v_sub_f32 v19, v19, v8
    v_sub_f32 v20, v20, v8
    v_sub_f32 v21, v21, v8
    v_sub_f32 v22, v22, v8
    v_sub_f32 v23, v23, v8
    v_sub_f32 v24, v24, v8
    v_cvt_pk_bf16_f32 v16, 0, v16
    v_cvt_pk_bf16_f32 v17, 0, v17
    v_cvt_pk_bf16_f32 v18, 0, v18
    v_cvt_pk_bf16_f32 v19, 0, v19
    v_cvt_pk_bf16_f32 v20, 0, v20
    v_cvt_pk_bf16_f32 v21, 0, v21
    v_cvt_pk_bf16_f32 v22, 0, v22
    v_cvt_pk_bf16_f32 v23, 0, v23
    v_cvt_pk_bf16_f32 v24, 0, v24
    v_mul_f32 v11, v16, v10
    v_fma_f32 v16, -v11, v9, v16
    v_fma_f32 v16, v16, v10, v11
    v_mul_f32 v11, v17, v10
    v_fma_f32 v17, -v11, v9, v17
    v_fma_f32 v17, v17, v10, v11
    v_mul_f32 v11, v18, v10
    v_fma_f32 v18, -v11, v9, v18
    v_fma_f32 v18, v18, v10, v11
    v_mul_f32 v11, v19, v10
    v_fma_f32 v19, -v11, v9, v19
    v_fma_f32 v19, v19, v10, v11
    v_mul_f32 v11, v20, v10
    v_fma_f32 v20, -v11, v9, v20
    v_fma_f32 v20, v20, v10, v11
    v_mul_f32 v11, v21, v10
    v_fma_f32 v21, -v11, v9, v21
    v_fma_f32 v21, v21, v10, v11
    v_mul_f32 v11, v22, v10
    v_fma_f32 v22, -v11, v9, v22
    v_fma_f32 v22, v22, v10, v11
    v_mul_f32 v11, v23, v10
    v_fma_f32 v23, -v11, v9, v23
    v_fma_f32 v23, v23, v10, v11
    v_mul_f32 v11, v24, v10
    v_fma_f32 v24, -v11, v9, v24
    v_fma_f32 v24, v24, v10, v11
    v_cvt_pk_bf16_f32 v16, v16, v16
    v_cvt_pk_bf16_f32 v17, v17, v17
    v_cvt_pk_bf16_f32 v18, v18, v18
    v_cvt_pk_bf16_f32 v19, v19, v19
    v_cvt_pk_bf16_f32 v20, v20, v20
    v_cvt_pk_bf16_f32 v21, v21, v21
    v_cvt_pk_bf16_f32 v22, v22, v22
    v_cvt_pk_bf16_f32 v23, v23, v23
    v_cvt_pk_bf16_f32 v24, v24, v24
    ds_write_b128 v1, v[16:19] offset:0
    ds_write_b128 v1, v[20:23] offset:16
    ds_write_b32 v25, v24 offset:2048
    ds_read2_b64 v[40:43], v15 offset0:0 offset1:1
    ds_read2_b64 v[44:47], v15 offset0:2 offset1:3
    ds_read2_b64 v[48:51], v15 offset0:4 offset1:5
    ds_read2_b64 v[52:55], v15 offset0:6 offset1:7
    ds_read_b64 v[56:57], v15 offset:64
    s_waitcnt lgkmcnt(0)
    s_add_u32 s32, s32, 0x9e3779b9
    s_xor_b32 s99, s32, s97
    v_mov_b32 v10, s99
    s_cmp_lg_u32 s3, 0
    s_cbranch_scc1 L_P1T
    v_and_b32 v32, v40, v4
    v_and_b32 v33, v40, v5
    v_and_b32 v34, v40, v6
    v_and_b32 v35, v40, v7
    s_waitcnt vmcnt(17)
    s_nop 0
    v_mfma_f32_16x16x32_bf16 v[28:31], v[64:67], v[32:35], 0
    v_and_b32 v36, v41, v4
    v_and_b32 v37, v41, v5
    v_and_b32 v38, v41, v6
    v_and_b32 v39, v41, v7
    s_waitcnt vmcnt(16)
    s_nop 0
    v_mfma_f32_16x16x32_bf16 v[28:31], v[68:71], v[36:39], v[28:31]
    v_and_b32 v32, v42, v4
    v_and_b32 v33, v42, v5
    v_and_b32 v34, v42, v6
    v_and_b32 v35, v42, v7
    s_waitcnt vmcnt(15)
    s_nop 0
    v_mfma_f32_16x16x32_bf16 v[28:31], v[72:75], v[32:35], v[28:31]
    v_and_b32 v36, v43, v4
    v_and_b32 v37, v43, v5
    v_and_b32 v38, v43, v6
    v_and_b32 v39, v43, v7
    s_waitcnt vmcnt(14)
    s_nop 0
    v_mfma_f32_16x16x32_bf16 v[28:31], v[76:79], v[36:39], v[28:31]
    v_and_b32 v32, v44, v4
    v_and_b32 v33, v44, v5
    v_and_b32 v34, v44, v6
    v_and_b32 v35, v44, v7
    s_waitcnt vmcnt(13)
    s_nop 0
    v_mfma_f32_16x16x32_bf16 v[28:31], v[80:83], v[32:35], v[28:31]
    v_and_b32 v36, v45, v4
    v_and_b32 v37, v45, v5
    v_and_b32 v38, v45, v6
    v_and_b32 v39, v45, v7
    s_waitcnt vmcnt(12)
    s_nop 0
    v_mfma_f32_16x16x32_bf16 v[28:31], v[84:87], v[36:39], v[28:31]
    v_and_b32 v32, v46, v4
    v_and_b32 v33, v46, v5
    v_and_b32 v34, v46, v6
    v_and_b32 v35, v46, v7
    s_waitcnt vmcnt(11)
    s_nop 0
    v_mfma_f32_16x16x32_bf16 v[28:31], v[88:91], v[32:35], v[28:31]
    v_and_b32 v36, v47, v4
    v_and_b32 v37, v47, v5
    v_and_b32 v38, v47, v6
    v_and_b32 v39, v47, v7
    s_waitcnt vmcnt(10)
    s_nop 0
    v_mfma_f32_16x16x32_bf16 v[28:31], v[92:95], v[36:39], v[28:31]
    v_and_b32 v32, v48, v4
    v_and_b32 v33, v48, v5
    v_and_b32 v34, v48, v6
    v_and_b32 v35, v48, v7
    s_waitcnt vmcnt(9)
    s_nop 0
    v_mfma_f32_16x16x32_bf16 v[28:31], v[96:99], v[32:35], v[28:31]
    v_and_b32 v36, v49, v4
    v_and_b32 v37, v49, v5
    v_and_b32 v38, v49, v6
    v_and_b32 v39, v49, v7
    s_waitcnt vmcnt(8)
    s_nop 0
    v_mfma_f32_16x16x32_bf16 v[28:31], v[100:103], v[36:39], v[28:31]
    v_and_b32 v32, v50, v4
    v_and_b32 v33, v50, v5
    v_and_b32 v34, v50, v6
    v_and_b32 v35, v50, v7
    s_waitcnt vmcnt(7)
    s_nop 0
    v_mfma_f32_16x16x32_bf16 v[28:31], v[104:107], v[32:35], v[28:31]
    v_and_b32 v36, v51, v4
    v_and_b32 v37, v51, v5
    v_and_b32 v38, v51, v6
    v_and_b32 v39, v51, v7
    s_waitcnt vmcnt(6)
    s_nop 0
    v_mfma_f32_16x16x32_bf16 v[28:31], v[108:111], v[36:39], v[28:31]
    v_and_b32 v32, v52, v4
    v_and_b32 v33, v52, v5
    v_and_b32 v34, v52, v6
    v_and_b32 v35, v52, v7
    s_waitcnt vmcnt(5)
    s_nop 0
    v_mfma_f32_16x16x32_bf16 v[28:31], v[112:115], v[32:35], v[28:31]
    v_and_b32 v36, v53, v4
    v_and_b32 v37, v53, v5
    v_and_b32 v38, v53, v6
    v_and_b32 v39, v53, v7
    s_waitcnt vmcnt(4)
    s_nop 0
    v_mfma_f32_16x16x32_bf16 v[28:31], v[116:119], v[36:39], v[28:31]
    v_and_b32 v32, v54, v4
    v_and_b32 v33, v54, v5
    v_and_b32 v34, v54, v6
    v_and_b32 v35, v54, v7
    s_waitcnt vmcnt(3)
    s_nop 0
    v_mfma_f32_16x16x32_bf16 v[28:31], v[120:123], v[32:35], v[28:31]
    v_and_b32 v36, v55, v4
    v_and_b32 v37, v55, v5
    v_and_b32 v38, v55, v6
    v_and_b32 v39, v55, v7
    s_waitcnt vmcnt(2)
    s_nop 0
    v_mfma_f32_16x16x32_bf16 v[28:31], v[124:127], v[36:39], v[28:31]
    v_and_b32 v32, v56, v4
    v_and_b32 v33, v56, v5
    v_and_b32 v34, v56, v6
    v_and_b32 v35, v56, v7
    s_waitcnt vmcnt(1)
    s_nop 0
    v_mfma_f32_16x16x32_bf16 v[28:31], v[128:131], v[32:35], v[28:31]
    v_and_b32 v36, v57, v4
    v_and_b32 v37, v57, v5
    v_and_b32 v38, v57, v6
    v_and_b32 v39, v57, v7
    s_waitcnt vmcnt(0)
    s_nop 0
    v_mfma_f32_16x16x32_bf16 v[28:31], v[132:135], v[36:39], v[28:31]
L_P1d:
    s_nop 7
    v_permlane32_swap_b32 v28, v29
    v_permlane32_swap_b32 v30, v31
    s_nop 0
    v_add_f32_dpp v8, v29, v28 row_ror:8 row_mask:0xf bank_mask:0x3
    s_nop 1
    v_add_f32_dpp v8, v30, v31 row_ror:8 row_mask:0xf bank_mask:0xc
    s_mov_b32 s34, 0x55555555
    s_or_b32 s35, s66, 4194304
    v_mov_b32_dpp v9, v8 quad_perm:[1,0,3,2] row_mask:0xf bank_mask:0xf
    s_mov_b32 exec_lo, s34
    s_mov_b32 exec_hi, s34
    buffer_store_dwordx4 v[8:11], v12, s[52:55], s35 offen
L_skippub:
    s_mov_b64 exec, -1
    s_cmp_lg_u32 s3, 0
    s_cbranch_scc1 L_TF
    s_bitset1_b32 s67, 22
    s_add_u32 s66, s67, 4096
    v_mov_b32 v7, 0
    v_mov_b32 v3, v25
    s_xor_b32 s65, s67, 8192
    s_xor_b32 s35, s35, 4194304
    v_and_b32 v13, 15, v0
    v_lshlrev_b32 v13, 9, v13
L_poll1:
    buffer_load_dword v15, v13, s[52:55], s65 offen offset:8 sc1
    buffer_load_dwordx3 v[16:18], v2, s[52:55], s67 offen offset:0 sc1
    buffer_load_dwordx3 v[20:22], v2, s[52:55], s67 offen offset:1024 sc1
    buffer_load_dwordx3 v[24:26], v2, s[52:55], s67 offen offset:2048 sc1
    buffer_load_dwordx3 v[28:30], v2, s[52:55], s67 offen offset:3072 sc1
    buffer_load_dwordx3 v[32:34], v2, s[52:55], s66 offen offset:0 sc1
    buffer_load_dwordx3 v[36:38], v2, s[52:55], s66 offen offset:1024 sc1
    buffer_load_dwordx3 v[40:42], v2, s[52:55], s66 offen offset:2048 sc1
    buffer_load_dwordx3 v[44:46], v2, s[52:55], s66 offen offset:3072 sc1
    s_waitcnt vmcnt(8)
    v_xor_b32 v15, s99, v15
    s_waitcnt vmcnt(7)
    v_bitop3_b32 v15, v18, s99, v15 bitop3:0xbe
    s_waitcnt vmcnt(6)
    v_bitop3_b32 v15, v22, s99, v15 bitop3:0xbe
    s_waitcnt vmcnt(5)
    v_bitop3_b32 v15, v26, s99, v15 bitop3:0xbe
    s_waitcnt vmcnt(4)
    v_bitop3_b32 v15, v30, s99, v15 bitop3:0xbe
    s_waitcnt vmcnt(3)
    v_bitop3_b32 v15, v34, s99, v15 bitop3:0xbe
    s_waitcnt vmcnt(2)
    v_bitop3_b32 v15, v38, s99, v15 bitop3:0xbe
    s_waitcnt vmcnt(1)
    v_bitop3_b32 v15, v42, s99, v15 bitop3:0xbe
    s_waitcnt vmcnt(0)
    v_bitop3_b32 v15, v46, s99, v15 bitop3:0xbe
    v_cmp_ne_u32 vcc, 0, v15
    s_cbranch_vccz L_got1
    s_sub_u32 s96, s96, 1
    s_cbranch_scc1 L_got1
    s_cmp_gt_u32 s96, 99976
    s_cbranch_scc1 L_poll1
    s_xor_b32 s65, s65, 4194304
    s_xor_b32 s66, s66, 4194304
    s_xor_b32 s67, s67, 4194304
    s_xor_b32 s99, s99, s97
    s_cmp_lg_u32 s96, 99976
    s_cbranch_scc1 L_poll1
    v_mov_b32 v10, s32
    s_mov_b32 exec_lo, s34
    s_mov_b32 exec_hi, s34
    buffer_store_dwordx4 v[8:11], v12, s[52:55], s35 offen sc1
    s_mov_b64 exec, -1
    s_branch L_poll1
L_got1:
    v_add_f32 v16, v16, v24
    v_add_f32 v32, v32, v40
    v_add_f32 v17, v17, v25
    v_add_f32 v33, v33, v41
    v_add_f32 v20, v20, v28
    v_add_f32 v36, v36, v44
    v_add_f32 v21, v21, v29
    v_add_f32 v37, v37, v45
    v_add_f32 v16, v16, v32
    v_add_f32 v17, v17, v33
    v_add_f32 v20, v20, v36
    v_add_f32 v21, v21, v37
    v_cvt_pk_bf16_f32 v16, v16, v17
    v_cvt_pk_bf16_f32 v20, v20, v21
    s_andn2_b32 s98, 4194304, s67
    s_or_b32 s33, s98, 1
    v_mov_b32 v17, s33
    ds_write2st64_b32 v3, v16, v20 offset0:9 offset1:10
    ds_write_b32 v7, v17 offset:2816
    s_cmp_eq_u32 s31, 0
    s_cbranch_scc1 L_A0O
    s_lshr_b32 s33, s28, 2
    s_mul_i32 s33, s33, 3
    s_add_u32 s33, s33, s31
    s_sub_u32 s33, s33, 1
    s_mov_b32 s96, 100000
    s_mul_i32 s60, s33, 192
    s_add_u32 s60, s60, 5242880
    s_add_u32 s61, s60, 147456
    v_lshrrev_b32 v8, 4, v0
    v_mul_u32_u24 v8, 36864, v8
    v_and_b32 v9, 15, v0
    v_lshl_add_u32 v8, v9, 4, v8
    v_and_b32 v6, 3, v0
    v_lshlrev_b32 v6, 6, v6
    v_and_or_b32 v6, v0, 44, v6
    s_mov_b32 s34, 0x0fff0fff
    s_mov_b32 exec_lo, s34
    s_mov_b32 exec_hi, s34
L_pollg:
    buffer_load_dwordx3 v[16:18], v8, s[52:55], s60 offen sc1
    buffer_load_dwordx3 v[20:22], v8, s[52:55], s61 offen sc1
    s_waitcnt vmcnt(0)
    v_xor_b32 v12, s32, v18
    v_bitop3_b32 v12, v22, s32, v12 bitop3:0xbe
    v_cmp_ne_u32 vcc, 0, v12
    s_cbranch_vccz L_gotg
    s_sleep 4
    s_xor_b32 s60, s60, s98
    s_xor_b32 s61, s61, s98
    s_sub_u32 s96, s96, 1
    s_cbranch_scc0 L_pollg
L_gotg:
    v_permlane32_swap_b32 v16, v17
    v_permlane32_swap_b32 v20, v21
    v_add_f32 v16, v16, v17
    v_add_f32 v20, v20, v21
    v_mov_b32 v17, v16
    v_mov_b32 v21, v20
    s_nop 0
    v_permlane16_swap_b32 v16, v17
    v_permlane16_swap_b32 v20, v21
    v_add_f32 v16, v16, v17
    v_add_f32 v20, v20, v21
    v_cvt_pk_bf16_f32 v16, 0, v16
    v_cvt_pk_bf16_f32 v20, 0, v20
    v_mul_f32 v17, 0xbfb8aa3b, v16
    v_exp_f32 v17, v17
    s_nop 0
    v_add_f32 v17, 1.0, v17
    v_rcp_f32 v17, v17
    s_nop 0
    v_mul_f32 v16, v16, v17
    v_cvt_pk_bf16_f32 v16, 0, v16
    v_mul_f32 v16, v16, v20
    v_cvt_pk_bf16_f32 v16, v16, v16
    ds_write_b32 v6, v16 offset:11412
    s_waitcnt lgkmcnt(0)
    s_and_b32 s34, s33, 7
    s_cbranch_scc1 L_Aend
    s_mov_b64 exec, -1
    s_lshr_b32 s33, s33, 3
    s_lshl_b32 s72, s33, 15
    s_add_u32 s72, s72, 2097152
    s_add_u32 s73, s72, 4096
    s_lshr_b32 s60, s33, 3
    s_mul_i32 s60, s60, 384
    s_and_b32 s61, s33, 3
    s_lshl_b32 s61, s61, 5
    s_add_u32 s60, s60, s61
    s_and_b32 s61, s33, 4
    s_lshl_b32 s61, s61, 2
    s_add_u32 s60, s60, s61
    v_lshrrev_b32 v63, 4, v0
    v_lshl_add_u32 v63, v63, 7, s60
    v_lshl_add_u32 v63, v14, 1, v63
    v_mov_b32 v62, 0
    s_mov_b64 s[56:57], s[22:23]
    s_mov_b32 s58, 1152
    s_mov_b32 s59, 0x20000
    buffer_load_short_d16_hi v62, v63, s[36:39], 0 offen
    s_mov_b32 s96, 100000
    v_mov_b32 v11, s32
    v_mov_b32 v48, 0
    v_mov_b32 v49, 0
    v_mov_b32 v50, 0
    ds_write_b96 v7, v[48:50] offset:2832
    s_waitcnt lgkmcnt(0)
    s_barrier
    s_barrier
    s_barrier
L_poll3o:
    buffer_load_dwordx4 v[16:19], v2, s[52:55], s72 offen offset:0 sc1
    buffer_load_dwordx4 v[20:23], v2, s[52:55], s72 offen offset:1024 sc1
    buffer_load_dwordx4 v[24:27], v2, s[52:55], s72 offen offset:2048 sc1
    buffer_load_dwordx4 v[28:31], v2, s[52:55], s72 offen offset:3072 sc1
    buffer_load_dwordx4 v[32:35], v2, s[52:55], s73 offen offset:0 sc1
    buffer_load_dwordx4 v[36:39], v2, s[52:55], s73 offen offset:1024 sc1
    buffer_load_dwordx4 v[40:43], v2, s[52:55], s73 offen offset:2048 sc1
    buffer_load_dwordx4 v[44:47], v2, s[52:55], s73 offen offset:3072 sc1
    ds_read_b96 v[48:50], v7 offset:2832
    ds_read2st64_b32 v[52:53], v3 offset0:0 offset1:1
    ds_read_b32 v54, v3 offset:512
    s_waitcnt lgkmcnt(0)
    v_add_f32 v52, v52, v53
    v_bitop3_b32 v48, v48, v49, v50 bitop3:0x80
    v_add_f32 v52, v52, v54
    v_cmp_eq_u32 s[4:5], 0, v48
    v_cvt_pk_bf16_f32 v52, 0, v52
    v_mul_f32 v53, 0xbfb8aa3b, v52
    v_exp_f32 v53, v53
    s_nop 0
    v_add_f32 v53, 1.0, v53
    v_rcp_f32 v53, v53
    s_nop 0
    v_mul_f32 v52, v52, v53
    v_cvt_pk_bf16_f32 v52, 0, v52
    s_waitcnt vmcnt(6)
    v_xor_b32 v12, s32, v19
    v_pk_add_f32 v[56:57], v[16:17], v[20:21]
    v_add_f32 v58, v18, v22
    v_bitop3_b32 v12, v23, s32, v12 bitop3:0xbe
    s_waitcnt vmcnt(5)
    v_pk_add_f32 v[56:57], v[56:57], v[24:25]
    v_add_f32 v58, v58, v26
    v_bitop3_b32 v12, v27, s32, v12 bitop3:0xbe
    s_waitcnt vmcnt(4)
    v_pk_add_f32 v[56:57], v[56:57], v[28:29]
    v_add_f32 v58, v58, v30
    v_bitop3_b32 v12, v31, s32, v12 bitop3:0xbe
    s_waitcnt vmcnt(3)
    v_pk_add_f32 v[56:57], v[56:57], v[32:33]
    v_add_f32 v58, v58, v34
    v_bitop3_b32 v12, v35, s32, v12 bitop3:0xbe
    s_waitcnt vmcnt(2)
    v_pk_add_f32 v[56:57], v[56:57], v[36:37]
    v_add_f32 v58, v58, v38
    v_bitop3_b32 v12, v39, s32, v12 bitop3:0xbe
    s_waitcnt vmcnt(1)
    v_pk_add_f32 v[56:57], v[56:57], v[40:41]
    v_add_f32 v58, v58, v42
    v_bitop3_b32 v12, v43, s32, v12 bitop3:0xbe
    s_waitcnt vmcnt(0)
    v_pk_add_f32 v[56:57], v[56:57], v[44:45]
    v_add_f32 v58, v58, v46
    v_bitop3_b32 v12, v47, s32, v12 bitop3:0xbe
    v_cmp_ne_u32 vcc, 0, v12
    s_cbranch_vccz L_poll3o_g
    s_sub_u32 s96, s96, 1
    s_cbranch_scc0 L_poll3o
L_poll3o_g:
    v_permlane32_swap_b32 v56, v58
    v_permlane32_swap_b32 v57, v59
    v_add_f32 v56, v56, v58
    v_add_f32 v57, v57, v59
    s_nop 1
    v_permlane16_swap_b32 v56, v57
    v_add_f32 v56, v56, v57
    s_nop 1
    v_add_f32_dpp v56, v56, v56 row_ror:8 row_mask:0xf bank_mask:0xf
    s_cmp_lg_u64 s[4:5], 0
    v_cvt_pk_bf16_f32 v56, 0, v56
    s_cbranch_scc1 L_fslow
L_fok:
    v_mul_f32 v56, v56, v52
    v_cvt_pk_bf16_f32 v56, 0, v56
    v_add_f32 v56, v56, v62
    v_cvt_pk_bf16_f32 v56, 0, v56
    s_mov_b32 exec_lo, 0x00ff00ff
    s_mov_b32 exec_hi, 0xff
    buffer_store_short_d16_hi v56, v63, s[56:59], 0 offen
    s_barrier
    s_branch L_Aend7
L_fslow:
    s_mov_b32 s96, 800000
L_fs1:
    ds_read_b96 v[48:50], v7 offset:2832
    ds_read2st64_b32 v[52:53], v3 offset0:0 offset1:1
    ds_read_b32 v54, v3 offset:512
    s_waitcnt lgkmcnt(0)
    v_add_f32 v52, v52, v53
    v_bitop3_b32 v48, v48, v49, v50 bitop3:0x80
    v_add_f32 v52, v52, v54
    v_cmp_eq_u32 s[4:5], 0, v48
    v_cvt_pk_bf16_f32 v52, 0, v52
    v_mul_f32 v53, 0xbfb8aa3b, v52
    v_exp_f32 v53, v53
    s_nop 0
    v_add_f32 v53, 1.0, v53
    v_rcp_f32 v53, v53
    s_nop 0
    v_mul_f32 v52, v52, v53
    v_cvt_pk_bf16_f32 v52, 0, v52
    s_cmp_eq_u64 s[4:5], 0
    s_cbranch_scc1 L_fok
    s_sub_u32 s96, s96, 1
    s_cbranch_scc0 L_fs1
    s_branch L_fok
L_Aend7:
    s_waitcnt vmcnt(0)
L_Aend:
    s_endpgm
L_A0O:
    v_lshlrev_b32 v6, 3, v0
    s_lshr_b32 s60, s28, 2
    s_lshl_b32 s60, s60, 13
    s_add_u32 s60, s60, 4718592
    s_add_u32 s61, s60, 4096
    s_mov_b32 s96, 100000
    s_mov_b32 s35, 0x3fb8aa3b
    s_barrier
    s_barrier
    buffer_load_dwordx4 v[16:19], v2, s[52:55], s60 offen offset:0 sc1
    buffer_load_dwordx4 v[20:23], v2, s[52:55], s60 offen offset:1024 sc1
    buffer_load_dwordx4 v[24:27], v2, s[52:55], s60 offen offset:2048 sc1
    buffer_load_dwordx4 v[28:31], v2, s[52:55], s60 offen offset:3072 sc1
    buffer_load_dwordx4 v[32:35], v2, s[52:55], s61 offen offset:0 sc1
    buffer_load_dwordx4 v[36:39], v2, s[52:55], s61 offen offset:1024 sc1
    buffer_load_dwordx4 v[40:43], v2, s[52:55], s61 offen offset:2048 sc1
    buffer_load_dwordx4 v[44:47], v2, s[52:55], s61 offen offset:3072 sc1
    s_branch L_poll2_w
L_poll2:
    s_and_b64 exec, s[4:5], s[4:5]
    s_cbranch_scc0 L_poll2_s0
    buffer_load_dwordx4 v[16:19], v2, s[52:55], s60 offen offset:0 sc1
L_poll2_s0:
    s_and_b64 exec, s[6:7], s[6:7]
    s_cbranch_scc0 L_poll2_s1
    buffer_load_dwordx4 v[20:23], v2, s[52:55], s60 offen offset:1024 sc1
L_poll2_s1:
    s_and_b64 exec, s[8:9], s[8:9]
    s_cbranch_scc0 L_poll2_s2
    buffer_load_dwordx4 v[24:27], v2, s[52:55], s60 offen offset:2048 sc1
L_poll2_s2:
    s_and_b64 exec, s[10:11], s[10:11]
    s_cbranch_scc0 L_poll2_s3
    buffer_load_dwordx4 v[28:31], v2, s[52:55], s60 offen offset:3072 sc1
L_poll2_s3:
    s_and_b64 exec, s[12:13], s[12:13]
    s_cbranch_scc0 L_poll2_s4
    buffer_load_dwordx4 v[32:35], v2, s[52:55], s61 offen offset:0 sc1
L_poll2_s4:
    s_and_b64 exec, s[14:15], s[14:15]
    s_cbranch_scc0 L_poll2_s5
    buffer_load_dwordx4 v[36:39], v2, s[52:55], s61 offen offset:1024 sc1
L_poll2_s5:
    s_and_b64 exec, s[16:17], s[16:17]
    s_cbranch_scc0 L_poll2_s6
    buffer_load_dwordx4 v[40:43], v2, s[52:55], s61 offen offset:2048 sc1
L_poll2_s6:
    s_and_b64 exec, s[18:19], s[18:19]
    s_cbranch_scc0 L_poll2_s7
    buffer_load_dwordx4 v[44:47], v2, s[52:55], s61 offen offset:3072 sc1
L_poll2_s7:
    s_mov_b64 exec, -1
L_poll2_w:
    s_waitcnt vmcnt(0)
    v_xor_b32 v12, s32, v19
    v_xor_b32 v13, s32, v35
    v_bitop3_b32 v12, v23, s32, v12 bitop3:0xbe
    v_bitop3_b32 v13, v39, s32, v13 bitop3:0xbe
    v_bitop3_b32 v12, v27, s32, v12 bitop3:0xbe
    v_bitop3_b32 v13, v43, s32, v13 bitop3:0xbe
    v_bitop3_b32 v12, v31, s32, v12 bitop3:0xbe
    v_bitop3_b32 v13, v47, s32, v13 bitop3:0xbe
    v_or_b32 v12, v12, v13
    v_cmp_ne_u32 vcc, 0, v12
    s_cbranch_vccz L_poll2_g
    v_cmp_ne_u32 s[4:5], s32, v19
    v_cmp_ne_u32 s[6:7], s32, v23
    v_cmp_ne_u32 s[8:9], s32, v27
    v_cmp_ne_u32 s[10:11], s32, v31
    v_cmp_ne_u32 s[12:13], s32, v35
    v_cmp_ne_u32 s[14:15], s32, v39
    v_cmp_ne_u32 s[16:17], s32, v43
    v_cmp_ne_u32 s[18:19], s32, v47
    s_sleep 1
    s_xor_b32 s60, s60, s98
    s_xor_b32 s61, s61, s98
    s_sub_u32 s96, s96, 1
    s_cbranch_scc0 L_poll2
L_poll2_g:
    v_max3_f32 v10, v18, v22, v26
    v_max3_f32 v11, v30, v34, v38
    v_max3_f32 v10, v10, v42, v46
    v_max_f32 v10, v10, v11
    v_mov_b32 v11, v10
    s_nop 1
    v_permlane32_swap_b32 v10, v11
    v_max_f32 v10, v10, v11
    s_nop 1
    v_mov_b32_dpp v10, v10 quad_perm:[0,0,2,2] row_mask:0xf bank_mask:0xf
    s_nop 1
    v_sub_f32_dpp v19, v18, v10 quad_perm:[0,0,2,2] row_mask:0xf bank_mask:0xf
    v_sub_f32_dpp v23, v22, v10 quad_perm:[0,0,2,2] row_mask:0xf bank_mask:0xf
    v_sub_f32_dpp v27, v26, v10 quad_perm:[0,0,2,2] row_mask:0xf bank_mask:0xf
    v_sub_f32_dpp v31, v30, v10 quad_perm:[0,0,2,2] row_mask:0xf bank_mask:0xf
    v_sub_f32_dpp v35, v34, v10 quad_perm:[0,0,2,2] row_mask:0xf bank_mask:0xf
    v_sub_f32_dpp v39, v38, v10 quad_perm:[0,0,2,2] row_mask:0xf bank_mask:0xf
    v_sub_f32_dpp v43, v42, v10 quad_perm:[0,0,2,2] row_mask:0xf bank_mask:0xf
    v_sub_f32_dpp v47, v46, v10 quad_perm:[0,0,2,2] row_mask:0xf bank_mask:0xf
    v_exp_f32 v19, v19
    v_exp_f32 v23, v23
    v_exp_f32 v27, v27
    v_exp_f32 v31, v31
    v_exp_f32 v35, v35
    v_exp_f32 v39, v39
    v_exp_f32 v43, v43
    v_exp_f32 v47, v47
    v_pk_mul_f32 v[8:9], v[16:17], v[18:19] op_sel:[0,1]
    v_mul_f32 v10, v18, v19
    v_pk_fma_f32 v[8:9], v[20:21], v[22:23], v[8:9] op_sel:[0,1,0]
    v_fmac_f32 v10, v22, v23
    v_pk_fma_f32 v[8:9], v[24:25], v[26:27], v[8:9] op_sel:[0,1,0]
    v_fmac_f32 v10, v26, v27
    v_pk_fma_f32 v[8:9], v[28:29], v[30:31], v[8:9] op_sel:[0,1,0]
    v_fmac_f32 v10, v30, v31
    v_pk_fma_f32 v[8:9], v[32:33], v[34:35], v[8:9] op_sel:[0,1,0]
    v_fmac_f32 v10, v34, v35
    v_pk_fma_f32 v[8:9], v[36:37], v[38:39], v[8:9] op_sel:[0,1,0]
    v_fmac_f32 v10, v38, v39
    v_pk_fma_f32 v[8:9], v[40:41], v[42:43], v[8:9] op_sel:[0,1,0]
    v_fmac_f32 v10, v42, v43
    v_pk_fma_f32 v[8:9], v[44:45], v[46:47], v[8:9] op_sel:[0,1,0]
    v_fmac_f32 v10, v46, v47
    v_mov_b32 v11, v8
    v_mov_b32 v12, v9
    v_mov_b32 v13, v10
    v_permlane32_swap_b32 v8, v11
    v_permlane32_swap_b32 v9, v12
    v_permlane32_swap_b32 v10, v13
    v_add_f32 v10, v10, v13
    v_add_f32 v8, v8, v11
    v_add_f32 v9, v9, v12
    v_rcp_f32_dpp v10, v10 quad_perm:[1,1,3,3] row_mask:0xf bank_mask:0xf
    s_nop 0
    v_mul_f32 v8, v8, v10
    v_mul_f32 v9, v9, v10
    v_cvt_pk_bf16_f32 v8, v8, v8
    v_cvt_pk_bf16_f32 v9, v9, v9
    s_mov_b32 exec_hi, 0
    ds_write_b64 v6, v[8:9] offset:11392
    s_waitcnt lgkmcnt(0)
    s_barrier
    s_endpgm
L_KV:
    s_sub_u32 s3, s3, 4
    v_and_b32 v1, 3, v0
    v_lshlrev_b32 v1, 10, v1
    v_and_b32 v3, 4, v0
    v_lshl_or_b32 v1, v3, 6, v1
    v_and_b32 v3, 8, v0
    v_lshl_or_b32 v1, v3, 3, v1
    v_and_or_b32 v1, v0, 48, v1
    s_lshl_b32 s60, s28, 17
    s_lshl_b32 s61, s3, 14
    s_add_u32 s60, s60, s61
    s_xor_b32 s61, s60, 4096
    s_xor_b32 s62, s60, 8192
    s_xor_b32 s63, s60, 12288
    s_brev_b32 s38, 64
    s_mov_b32 s42, s38
    s_waitcnt lgkmcnt(0)
    s_mov_b64 s[36:37], s[6:7]
    s_mov_b64 s[40:41], s[8:9]
    s_barrier
    buffer_load_dwordx4 v[40:43], v1, s[36:39], s60 offen offset:0 nt
    buffer_load_dwordx4 v[44:47], v1, s[36:39], s60 offen offset:128 nt
    buffer_load_dwordx4 v[48:51], v1, s[36:39], s60 offen offset:512 nt
    v_and_b32 v9, 1, v0
    v_lshlrev_b32 v9, 4, v9
    v_mov_b32 v10, 0xffff
    v_lshlrev_b32 v9, v9, v10
    v_bfe_u32 v10, v0, 1, 2
    v_cmp_eq_u32 s[68:69], 0, v10
    v_cmp_eq_u32 s[70:71], 1, v10
    v_cmp_eq_u32 s[72:73], 2, v10
    v_cmp_eq_u32 s[74:75], 3, v10
    v_cndmask_b32 v4, 0, v9, s[68:69]
    v_cndmask_b32 v5, 0, v9, s[70:71]
    v_cndmask_b32 v6, 0, v9, s[72:73]
    v_cndmask_b32 v7, 0, v9, s[74:75]
    v_bfe_u32 v16, v0, 3, 1
    v_lshlrev_b32 v16, 8, v16
    v_and_or_b32 v16, v0, 48, v16
    v_mov_b32 v18, 0
    v_and_b32 v17, 4, v0
    v_lshl_or_b32 v16, v17, 4, v16
    s_mov_b32 s96, 800000
    s_waitcnt vmcnt(2)
    buffer_load_dwordx4 v[52:55], v1, s[36:39], s60 offen offset:640 nt
    s_waitcnt vmcnt(2)
    buffer_load_dwordx4 v[56:59], v1, s[36:39], s61 offen offset:0 nt
    s_waitcnt vmcnt(2)
    buffer_load_dwordx4 v[60:63], v1, s[36:39], s61 offen offset:128 nt
    s_waitcnt vmcnt(2)
    buffer_load_dwordx4 v[64:67], v1, s[36:39], s61 offen offset:512 nt
    s_waitcnt vmcnt(2)
    buffer_load_dwordx4 v[68:71], v1, s[36:39], s61 offen offset:640 nt
    s_waitcnt vmcnt(2)
    buffer_load_dwordx4 v[72:75], v1, s[36:39], s62 offen offset:0 nt
    s_waitcnt vmcnt(2)
    buffer_load_dwordx4 v[76:79], v1, s[36:39], s62 offen offset:128 nt
    s_waitcnt vmcnt(2)
    buffer_load_dwordx4 v[80:83], v1, s[36:39], s62 offen offset:512 nt
    s_waitcnt vmcnt(2)
    buffer_load_dwordx4 v[84:87], v1, s[36:39], s62 offen offset:640 nt
    s_waitcnt vmcnt(2)
    buffer_load_dwordx4 v[88:91], v1, s[36:39], s63 offen offset:0 nt
    s_waitcnt vmcnt(2)
    buffer_load_dwordx4 v[92:95], v1, s[36:39], s63 offen offset:128 nt
    s_waitcnt vmcnt(2)
    buffer_load_dwordx4 v[96:99], v1, s[36:39], s63 offen offset:512 nt
    s_waitcnt vmcnt(2)
    buffer_load_dwordx4 v[100:103], v1, s[36:39], s63 offen offset:640 nt
    s_waitcnt vmcnt(2)
    buffer_load_dwordx4 v[104:107], v2, s[40:43], s60 offen offset:0 nt
    s_waitcnt vmcnt(2)
    buffer_load_dwordx4 v[108:111], v2, s[40:43], s60 offen offset:1024 nt
    s_waitcnt vmcnt(2)
    buffer_load_dwordx4 v[112:115], v2, s[40:43], s60 offen offset:2048 nt
    s_waitcnt vmcnt(2)
    buffer_load_dwordx4 v[116:119], v2, s[40:43], s60 offen offset:3072 nt
L_qwait:
    ds_read_b32 v17, v18 offset:2816
    ds_read_b128 v[8:11], v16 offset:2304
    ds_read_b128 v[12:15], v16 offset:2432
    s_waitcnt lgkmcnt(0)
    v_cmp_eq_u32 vcc, 0, v17
    s_cbranch_vccz L_qgot
    s_sleep 2
    s_sub_u32 s96, s96, 1
    s_cbranch_scc0 L_qwait
L_qgot:
    buffer_load_dwordx4 v[120:123], v2, s[40:43], s61 offen offset:0 nt
    buffer_load_dwordx4 v[124:127], v2, s[40:43], s61 offen offset:1024 nt
    v_mfma_f32_16x16x32_bf16 v[16:19], v[40:43], v[8:11], 0
    v_mfma_f32_16x16x32_bf16 v[32:35], v[48:51], v[8:11], 0
    v_mfma_f32_16x16x32_bf16 v[20:23], v[56:59], v[8:11], 0
    v_mfma_f32_16x16x32_bf16 v[36:39], v[64:67], v[8:11], 0
    v_mfma_f32_16x16x32_bf16 v[16:19], v[44:47], v[12:15], v[16:19]
    v_mfma_f32_16x16x32_bf16 v[32:35], v[52:55], v[12:15], v[32:35]
    v_mfma_f32_16x16x32_bf16 v[20:23], v[60:63], v[12:15], v[20:23]
    v_mfma_f32_16x16x32_bf16 v[36:39], v[68:71], v[12:15], v[36:39]
    v_mfma_f32_16x16x32_bf16 v[24:27], v[72:75], v[8:11], 0
    v_mfma_f32_16x16x32_bf16 v[40:43], v[80:83], v[8:11], 0
    v_mfma_f32_16x16x32_bf16 v[28:31], v[88:91], v[8:11], 0
    v_mfma_f32_16x16x32_bf16 v[44:47], v[96:99], v[8:11], 0
    v_mfma_f32_16x16x32_bf16 v[24:27], v[76:79], v[12:15], v[24:27]
    v_mfma_f32_16x16x32_bf16 v[40:43], v[84:87], v[12:15], v[40:43]
    v_mfma_f32_16x16x32_bf16 v[28:31], v[92:95], v[12:15], v[28:31]
    v_mfma_f32_16x16x32_bf16 v[44:47], v[100:103], v[12:15], v[44:47]
    s_mov_b32 s33, 0x3db504f3
    s_mov_b32 s35, 0x3fb8aa3b
    s_waitcnt vmcnt(4)
    buffer_load_dwordx4 v[128:131], v2, s[40:43], s61 offen offset:2048 nt
    v_permlane32_swap_b32 v16, v32
    v_permlane32_swap_b32 v17, v33
    v_permlane32_swap_b32 v18, v34
    v_permlane32_swap_b32 v19, v35
    v_permlane32_swap_b32 v20, v36
    v_permlane32_swap_b32 v21, v37
    v_permlane32_swap_b32 v22, v38
    v_permlane32_swap_b32 v23, v39
    v_permlane32_swap_b32 v24, v40
    v_permlane32_swap_b32 v25, v41
    v_permlane32_swap_b32 v26, v42
    v_permlane32_swap_b32 v27, v43
    v_permlane32_swap_b32 v28, v44
    v_permlane32_swap_b32 v29, v45
    v_permlane32_swap_b32 v30, v46
    v_permlane32_swap_b32 v31, v47
    v_add_f32_dpp v16, v32, v16 row_shl:4 row_mask:0xf bank_mask:0x5
    v_add_f32_dpp v17, v33, v17 row_shl:4 row_mask:0xf bank_mask:0x5
    v_add_f32_dpp v18, v34, v18 row_shl:4 row_mask:0xf bank_mask:0x5
    v_add_f32_dpp v19, v35, v19 row_shl:4 row_mask:0xf bank_mask:0x5
    v_add_f32_dpp v20, v36, v20 row_shl:4 row_mask:0xf bank_mask:0x5
    v_add_f32_dpp v21, v37, v21 row_shl:4 row_mask:0xf bank_mask:0x5
    v_add_f32_dpp v22, v38, v22 row_shl:4 row_mask:0xf bank_mask:0x5
    v_add_f32_dpp v23, v39, v23 row_shl:4 row_mask:0xf bank_mask:0x5
    v_add_f32_dpp v24, v40, v24 row_shl:4 row_mask:0xf bank_mask:0x5
    v_add_f32_dpp v25, v41, v25 row_shl:4 row_mask:0xf bank_mask:0x5
    v_add_f32_dpp v26, v42, v26 row_shl:4 row_mask:0xf bank_mask:0x5
    v_add_f32_dpp v27, v43, v27 row_shl:4 row_mask:0xf bank_mask:0x5
    v_add_f32_dpp v28, v44, v28 row_shl:4 row_mask:0xf bank_mask:0x5
    v_add_f32_dpp v29, v45, v29 row_shl:4 row_mask:0xf bank_mask:0x5
    v_add_f32_dpp v30, v46, v30 row_shl:4 row_mask:0xf bank_mask:0x5
    v_add_f32_dpp v31, v47, v31 row_shl:4 row_mask:0xf bank_mask:0x5
    v_mov_b32_dpp v16, v16 row_shr:4 row_mask:0xf bank_mask:0xa
    v_mov_b32_dpp v17, v17 row_shr:4 row_mask:0xf bank_mask:0xa
    v_mov_b32_dpp v18, v18 row_shr:4 row_mask:0xf bank_mask:0xa
    v_mov_b32_dpp v19, v19 row_shr:4 row_mask:0xf bank_mask:0xa
    v_mov_b32_dpp v20, v20 row_shr:4 row_mask:0xf bank_mask:0xa
    v_mov_b32_dpp v21, v21 row_shr:4 row_mask:0xf bank_mask:0xa
    v_mov_b32_dpp v22, v22 row_shr:4 row_mask:0xf bank_mask:0xa
    v_mov_b32_dpp v23, v23 row_shr:4 row_mask:0xf bank_mask:0xa
    v_mov_b32_dpp v24, v24 row_shr:4 row_mask:0xf bank_mask:0xa
    v_mov_b32_dpp v25, v25 row_shr:4 row_mask:0xf bank_mask:0xa
    v_mov_b32_dpp v26, v26 row_shr:4 row_mask:0xf bank_mask:0xa
    v_mov_b32_dpp v27, v27 row_shr:4 row_mask:0xf bank_mask:0xa
    v_mov_b32_dpp v28, v28 row_shr:4 row_mask:0xf bank_mask:0xa
    v_mov_b32_dpp v29, v29 row_shr:4 row_mask:0xf bank_mask:0xa
    v_mov_b32_dpp v30, v30 row_shr:4 row_mask:0xf bank_mask:0xa
    v_mov_b32_dpp v31, v31 row_shr:4 row_mask:0xf bank_mask:0xa
    s_waitcnt vmcnt(4)
    buffer_load_dwordx4 v[132:135], v2, s[40:43], s61 offen offset:3072 nt
    v_cvt_pk_bf16_f32 v16, 0, v16
    v_cvt_pk_bf16_f32 v17, 0, v17
    v_cvt_pk_bf16_f32 v18, 0, v18
    v_cvt_pk_bf16_f32 v19, 0, v19
    v_cvt_pk_bf16_f32 v20, 0, v20
    v_cvt_pk_bf16_f32 v21, 0, v21
    v_cvt_pk_bf16_f32 v22, 0, v22
    v_cvt_pk_bf16_f32 v23, 0, v23
    v_cvt_pk_bf16_f32 v24, 0, v24
    v_cvt_pk_bf16_f32 v25, 0, v25
    v_cvt_pk_bf16_f32 v26, 0, v26
    v_cvt_pk_bf16_f32 v27, 0, v27
    v_cvt_pk_bf16_f32 v28, 0, v28
    v_cvt_pk_bf16_f32 v29, 0, v29
    v_cvt_pk_bf16_f32 v30, 0, v30
    v_cvt_pk_bf16_f32 v31, 0, v31
    v_mul_f32 v16, s33, v16
    v_mul_f32 v17, s33, v17
    v_mul_f32 v18, s33, v18
    v_mul_f32 v19, s33, v19
    v_mul_f32 v20, s33, v20
    v_mul_f32 v21, s33, v21
    v_mul_f32 v22, s33, v22
    v_mul_f32 v23, s33, v23
    v_mul_f32 v24, s33, v24
    v_mul_f32 v25, s33, v25
    v_mul_f32 v26, s33, v26
    v_mul_f32 v27, s33, v27
    v_mul_f32 v28, s33, v28
    v_mul_f32 v29, s33, v29
    v_mul_f32 v30, s33, v30
    v_mul_f32 v31, s33, v31
    v_cvt_pk_bf16_f32 v16, 0, v16
    v_cvt_pk_bf16_f32 v17, 0, v17
    v_cvt_pk_bf16_f32 v18, 0, v18
    v_cvt_pk_bf16_f32 v19, 0, v19
    v_cvt_pk_bf16_f32 v20, 0, v20
    v_cvt_pk_bf16_f32 v21, 0, v21
    v_cvt_pk_bf16_f32 v22, 0, v22
    v_cvt_pk_bf16_f32 v23, 0, v23
    v_cvt_pk_bf16_f32 v24, 0, v24
    v_cvt_pk_bf16_f32 v25, 0, v25
    v_cvt_pk_bf16_f32 v26, 0, v26
    v_cvt_pk_bf16_f32 v27, 0, v27
    v_cvt_pk_bf16_f32 v28, 0, v28
    v_cvt_pk_bf16_f32 v29, 0, v29
    v_cvt_pk_bf16_f32 v30, 0, v30
    v_cvt_pk_bf16_f32 v31, 0, v31
    s_waitcnt vmcnt(4)
    buffer_load_dwordx4 v[136:139], v2, s[40:43], s62 offen offset:0 nt
    v_max3_f32 v10, v16, v17, v18
    v_max3_f32 v11, v19, v20, v21
    v_max3_f32 v10, v10, v22, v23
    v_max3_f32 v11, v11, v24, v25
    v_max3_f32 v10, v10, v26, v27
    v_max3_f32 v11, v11, v28, v29
    v_max3_f32 v10, v10, v30, v31
    v_max_f32 v10, v10, v11
    v_mov_b32 v11, v10
    s_nop 1
    v_permlane16_swap_b32 v10, v11
    v_max_f32 v10, v10, v11
    v_mov_b32 v11, v10
    s_nop 1
    v_permlane32_swap_b32 v10, v11
    v_max_f32 v10, v10, v11
    v_mul_f32 v10, s35, v10
    v_fma_f32 v16, v16, s35, -v10
    v_fma_f32 v17, v17, s35, -v10
    v_fma_f32 v18, v18, s35, -v10
    v_fma_f32 v19, v19, s35, -v10
    v_fma_f32 v20, v20, s35, -v10
    v_fma_f32 v21, v21, s35, -v10
    v_fma_f32 v22, v22, s35, -v10
    v_fma_f32 v23, v23, s35, -v10
    v_fma_f32 v24, v24, s35, -v10
    v_fma_f32 v25, v25, s35, -v10
    v_fma_f32 v26, v26, s35, -v10
    v_fma_f32 v27, v27, s35, -v10
    v_fma_f32 v28, v28, s35, -v10
    v_fma_f32 v29, v29, s35, -v10
    v_fma_f32 v30, v30, s35, -v10
    v_fma_f32 v31, v31, s35, -v10
    v_exp_f32 v16, v16
    v_exp_f32 v17, v17
    v_exp_f32 v18, v18
    v_exp_f32 v19, v19
    v_exp_f32 v20, v20
    v_exp_f32 v21, v21
    v_exp_f32 v22, v22
    v_exp_f32 v23, v23
    v_exp_f32 v24, v24
    v_exp_f32 v25, v25
    v_exp_f32 v26, v26
    v_exp_f32 v27, v27
    v_exp_f32 v28, v28
    v_exp_f32 v29, v29
    v_exp_f32 v30, v30
    v_exp_f32 v31, v31
    s_waitcnt vmcnt(4)
    buffer_load_dwordx4 v[140:143], v2, s[40:43], s62 offen offset:1024 nt
    v_add_f32 v11, v16, v17
    v_add_f32 v9, v18, v19
    v_add_f32 v11, v11, v20
    v_add_f32 v9, v9, v21
    v_add_f32 v11, v11, v22
    v_add_f32 v9, v9, v23
    v_add_f32 v11, v11, v24
    v_add_f32 v9, v9, v25
    v_add_f32 v11, v11, v26
    v_add_f32 v9, v9, v27
    v_add_f32 v11, v11, v28
    v_add_f32 v9, v9, v29
    v_add_f32 v11, v11, v30
    v_add_f32 v9, v9, v31
    v_add_f32 v11, v11, v9
    v_cvt_pk_bf16_f32 v16, v16, v16
    v_cvt_pk_bf16_f32 v17, v17, v17
    v_cvt_pk_bf16_f32 v18, v18, v18
    v_cvt_pk_bf16_f32 v19, v19, v19
    v_cvt_pk_bf16_f32 v20, v20, v20
    v_cvt_pk_bf16_f32 v21, v21, v21
    v_cvt_pk_bf16_f32 v22, v22, v22
    v_cvt_pk_bf16_f32 v23, v23, v23
    v_cvt_pk_bf16_f32 v24, v24, v24
    v_cvt_pk_bf16_f32 v25, v25, v25
    v_cvt_pk_bf16_f32 v26, v26, v26
    v_cvt_pk_bf16_f32 v27, v27, v27
    v_cvt_pk_bf16_f32 v28, v28, v28
    v_cvt_pk_bf16_f32 v29, v29, v29
    v_cvt_pk_bf16_f32 v30, v30, v30
    v_cvt_pk_bf16_f32 v31, v31, v31
    v_mov_b32 v9, v11
    s_nop 1
    v_permlane16_swap_b32 v11, v9
    v_add_f32 v11, v11, v9
    v_mov_b32 v9, v11
    s_nop 1
    v_permlane32_swap_b32 v11, v9
    v_add_f32 v11, v11, v9
    v_bfe_u32 v8, v0, 3, 1
    s_lshl_b32 s33, s3, 3
    v_lshl_add_u32 v9, v8, 6, s33
    ds_write_b64 v9, v[10:11] offset:11264
    s_waitcnt vmcnt(4)
    buffer_load_dwordx4 v[144:147], v2, s[40:43], s62 offen offset:2048 nt
    v_and_b32 v9, 7, v0
    v_lshlrev_b32 v9, 2, v9
    v_lshl_or_b32 v9, v8, 9, v9
    v_lshrrev_b32 v8, 4, v0
    v_lshl_or_b32 v9, v8, 7, v9
    s_lshl_b32 s33, s3, 10
    v_add_u32 v9, s33, v9
    v_and_b32 v32, v16, v4
    v_and_b32 v33, v16, v5
    v_and_b32 v34, v16, v6
    v_and_b32 v35, v16, v7
    s_nop 1
    v_mfma_f32_16x16x32_bf16 v[12:15], v[104:107], v[32:35], 0
    v_and_b32 v36, v17, v4
    v_and_b32 v37, v17, v5
    v_and_b32 v38, v17, v6
    v_and_b32 v39, v17, v7
    s_nop 1
    v_mfma_f32_16x16x32_bf16 v[12:15], v[108:111], v[36:39], v[12:15]
    v_and_b32 v32, v18, v4
    v_and_b32 v33, v18, v5
    v_and_b32 v34, v18, v6
    v_and_b32 v35, v18, v7
    s_nop 1
    v_mfma_f32_16x16x32_bf16 v[12:15], v[112:115], v[32:35], v[12:15]
    v_and_b32 v36, v19, v4
    v_and_b32 v37, v19, v5
    v_and_b32 v38, v19, v6
    v_and_b32 v39, v19, v7
    s_nop 1
    v_mfma_f32_16x16x32_bf16 v[12:15], v[116:119], v[36:39], v[12:15]
    v_and_b32 v32, v20, v4
    v_and_b32 v33, v20, v5
    v_and_b32 v34, v20, v6
    v_and_b32 v35, v20, v7
    s_nop 1
    v_mfma_f32_16x16x32_bf16 v[12:15], v[120:123], v[32:35], v[12:15]
    v_and_b32 v36, v21, v4
    v_and_b32 v37, v21, v5
    v_and_b32 v38, v21, v6
    v_and_b32 v39, v21, v7
    s_nop 1
    v_mfma_f32_16x16x32_bf16 v[12:15], v[124:127], v[36:39], v[12:15]
    v_and_b32 v32, v22, v4
    v_and_b32 v33, v22, v5
    v_and_b32 v34, v22, v6
    v_and_b32 v35, v22, v7
    s_waitcnt vmcnt(4)
    buffer_load_dwordx4 v[148:151], v2, s[40:43], s62 offen offset:3072 nt
    v_mfma_f32_16x16x32_bf16 v[12:15], v[128:131], v[32:35], v[12:15]
    v_and_b32 v36, v23, v4
    v_and_b32 v37, v23, v5
    v_and_b32 v38, v23, v6
    v_and_b32 v39, v23, v7
    s_waitcnt vmcnt(4)
    buffer_load_dwordx4 v[152:155], v2, s[40:43], s63 offen offset:0 nt
    v_mfma_f32_16x16x32_bf16 v[12:15], v[132:135], v[36:39], v[12:15]
    v_and_b32 v32, v24, v4
    v_and_b32 v33, v24, v5
    v_and_b32 v34, v24, v6
    v_and_b32 v35, v24, v7
    s_waitcnt vmcnt(4)
    buffer_load_dwordx4 v[156:159], v2, s[40:43], s63 offen offset:1024 nt
    v_mfma_f32_16x16x32_bf16 v[12:15], v[136:139], v[32:35], v[12:15]
    v_and_b32 v36, v25, v4
    v_and_b32 v37, v25, v5
    v_and_b32 v38, v25, v6
    v_and_b32 v39, v25, v7
    s_waitcnt vmcnt(4)
    buffer_load_dwordx4 v[160:163], v2, s[40:43], s63 offen offset:2048 nt
    v_mfma_f32_16x16x32_bf16 v[12:15], v[140:143], v[36:39], v[12:15]
    v_and_b32 v32, v26, v4
    v_and_b32 v33, v26, v5
    v_and_b32 v34, v26, v6
    v_and_b32 v35, v26, v7
    s_waitcnt vmcnt(4)
    buffer_load_dwordx4 v[164:167], v2, s[40:43], s63 offen offset:3072 nt
    v_mfma_f32_16x16x32_bf16 v[12:15], v[144:147], v[32:35], v[12:15]
    v_and_b32 v36, v27, v4
    v_and_b32 v37, v27, v5
    v_and_b32 v38, v27, v6
    v_and_b32 v39, v27, v7
    s_waitcnt vmcnt(4)
    s_nop 0
    v_mfma_f32_16x16x32_bf16 v[12:15], v[148:151], v[36:39], v[12:15]
    v_and_b32 v32, v28, v4
    v_and_b32 v33, v28, v5
    v_and_b32 v34, v28, v6
    v_and_b32 v35, v28, v7
    s_waitcnt vmcnt(3)
    s_nop 0
    v_mfma_f32_16x16x32_bf16 v[12:15], v[152:155], v[32:35], v[12:15]
    v_and_b32 v36, v29, v4
    v_and_b32 v37, v29, v5
    v_and_b32 v38, v29, v6
    v_and_b32 v39, v29, v7
    s_waitcnt vmcnt(2)
    s_nop 0
    v_mfma_f32_16x16x32_bf16 v[12:15], v[156:159], v[36:39], v[12:15]
    v_and_b32 v32, v30, v4
    v_and_b32 v33, v30, v5
    v_and_b32 v34, v30, v6
    v_and_b32 v35, v30, v7
    s_waitcnt vmcnt(1)
    s_nop 0
    v_mfma_f32_16x16x32_bf16 v[12:15], v[160:163], v[32:35], v[12:15]
    v_and_b32 v36, v31, v4
    v_and_b32 v37, v31, v5
    v_and_b32 v38, v31, v6
    v_and_b32 v39, v31, v7
    s_waitcnt vmcnt(0)
    s_nop 0
    v_mfma_f32_16x16x32_bf16 v[12:15], v[164:167], v[36:39], v[12:15]
    s_nop 7
    ds_write_b32 v9, v12 offset:3072
    ds_write_b32 v9, v13 offset:3104
    ds_write_b32 v9, v14 offset:3136
    ds_write_b32 v9, v15 offset:3168
    s_waitcnt lgkmcnt(0)
    s_barrier
    s_endpgm
L_Tpar:
    s_sub_u32 s29, s3, 1
    s_cmp_eq_u32 s31, 0
    s_cbranch_scc1 L_TO
    s_bfe_u32 s33, s28, 0x30002
    s_mul_i32 s33, s33, 3
    s_add_u32 s33, s33, s31
    s_sub_u32 s33, s33, 1
    s_mul_i32 s33, s33, 3
    s_add_u32 s33, s33, s29
    s_mul_i32 s34, s33, 57
    s_lshr_b32 s34, s34, 9
    s_lshr_b32 s35, s28, 5
    s_sub_u32 s35, s35, s34
    s_mul_i32 s35, s35, 9
    s_add_u32 s33, s33, s35
    s_mul_i32 s35, s34, 72
    s_add_u32 s35, s35, s33
    s_lshl_b32 s66, s35, 9
    s_add_u32 s66, s66, 1048576
    s_lshl_b32 s33, s33, 7
    s_and_b32 s30, s34, 3
    s_mul_i32 s60, s30, 1327104
    s_add_u32 s60, s60, s33
    s_movk_i32 s61, 9216
    s_mov_b32 s42, 5308416
    v_mul_u32_u24 v3, 165888, v13
    s_cmp_lt_u32 s34, 4
    s_waitcnt lgkmcnt(0)
    s_cselect_b64 s[40:41], s[16:17], s[18:19]
    s_barrier
    s_mov_b64 s[36:37], s[4:5]
    v_lshl_add_u32 v3, v14, 4, v3
    buffer_load_dwordx4 v[8:11], v2, s[36:39], 0 offen
    buffer_load_short_d16_hi v24, v1, s[36:39], 0 offen offset:1024
    buffer_load_dwordx4 v[64:67], v3, s[40:43], s60 offen nt
    s_add_u32 s60, s60, s61
    buffer_load_dwordx4 v[68:71], v3, s[40:43], s60 offen nt
    s_add_u32 s60, s60, s61
    buffer_load_dwordx4 v[72:75], v3, s[40:43], s60 offen nt
    s_add_u32 s60, s60, s61
    buffer_load_dwordx4 v[76:79], v3, s[40:43], s60 offen nt
    s_add_u32 s60, s60, s61
    buffer_load_dwordx4 v[80:83], v3, s[40:43], s60 offen nt
    s_add_u32 s60, s60, s61
    s_mov_b32 s97, 0
    s_branch L_P1b
L_P1T:
    v_and_b32 v32, v40, v4
    v_and_b32 v33, v40, v5
    v_and_b32 v34, v40, v6
    v_and_b32 v35, v40, v7
    s_waitcnt vmcnt(4)
    buffer_load_dwordx4 v[84:87], v3, s[40:43], s60 offen nt
    s_add_u32 s60, s60, s61
    v_mfma_f32_16x16x32_bf16 v[28:31], v[64:67], v[32:35], 0
    v_and_b32 v36, v41, v4
    v_and_b32 v37, v41, v5
    v_and_b32 v38, v41, v6
    v_and_b32 v39, v41, v7
    s_waitcnt vmcnt(4)
    buffer_load_dwordx4 v[88:91], v3, s[40:43], s60 offen nt
    s_add_u32 s60, s60, s61
    v_mfma_f32_16x16x32_bf16 v[28:31], v[68:71], v[36:39], v[28:31]
    v_and_b32 v32, v42, v4
    v_and_b32 v33, v42, v5
    v_and_b32 v34, v42, v6
    v_and_b32 v35, v42, v7
    s_waitcnt vmcnt(4)
    buffer_load_dwordx4 v[92:95], v3, s[40:43], s60 offen nt
    s_add_u32 s60, s60, s61
    v_mfma_f32_16x16x32_bf16 v[28:31], v[72:75], v[32:35], v[28:31]
    v_and_b32 v36, v43, v4
    v_and_b32 v37, v43, v5
    v_and_b32 v38, v43, v6
    v_and_b32 v39, v43, v7
    s_waitcnt vmcnt(4)
    buffer_load_dwordx4 v[96:99], v3, s[40:43], s60 offen nt
    s_add_u32 s60, s60, s61
    v_mfma_f32_16x16x32_bf16 v[28:31], v[76:79], v[36:39], v[28:31]
    v_and_b32 v32, v44, v4
    v_and_b32 v33, v44, v5
    v_and_b32 v34, v44, v6
    v_and_b32 v35, v44, v7
    s_waitcnt vmcnt(4)
    buffer_load_dwordx4 v[100:103], v3, s[40:43], s60 offen nt
    s_add_u32 s60, s60, s61
    v_mfma_f32_16x16x32_bf16 v[28:31], v[80:83], v[32:35], v[28:31]
    v_and_b32 v36, v45, v4
    v_and_b32 v37, v45, v5
    v_and_b32 v38, v45, v6
    v_and_b32 v39, v45, v7
    s_waitcnt vmcnt(4)
    buffer_load_dwordx4 v[104:107], v3, s[40:43], s60 offen nt
    s_add_u32 s60, s60, s61
    v_mfma_f32_16x16x32_bf16 v[28:31], v[84:87], v[36:39], v[28:31]
    v_and_b32 v32, v46, v4
    v_and_b32 v33, v46, v5
    v_and_b32 v34, v46, v6
    v_and_b32 v35, v46, v7
    s_waitcnt vmcnt(4)
    buffer_load_dwordx4 v[108:111], v3, s[40:43], s60 offen nt
    s_add_u32 s60, s60, s61
    v_mfma_f32_16x16x32_bf16 v[28:31], v[88:91], v[32:35], v[28:31]
    v_and_b32 v36, v47, v4
    v_and_b32 v37, v47, v5
    v_and_b32 v38, v47, v6
    v_and_b32 v39, v47, v7
    s_waitcnt vmcnt(4)
    buffer_load_dwordx4 v[112:115], v3, s[40:43], s60 offen nt
    s_add_u32 s60, s60, s61
    v_mfma_f32_16x16x32_bf16 v[28:31], v[92:95], v[36:39], v[28:31]
    v_and_b32 v32, v48, v4
    v_and_b32 v33, v48, v5
    v_and_b32 v34, v48, v6
    v_and_b32 v35, v48, v7
    s_waitcnt vmcnt(4)
    buffer_load_dwordx4 v[116:119], v3, s[40:43], s60 offen nt
    s_add_u32 s60, s60, s61
    v_mfma_f32_16x16x32_bf16 v[28:31], v[96:99], v[32:35], v[28:31]
    v_and_b32 v36, v49, v4
    v_and_b32 v37, v49, v5
    v_and_b32 v38, v49, v6
    v_and_b32 v39, v49, v7
    s_waitcnt vmcnt(4)
    buffer_load_dwordx4 v[120:123], v3, s[40:43], s60 offen nt
    s_add_u32 s60, s60, s61
    v_mfma_f32_16x16x32_bf16 v[28:31], v[100:103], v[36:39], v[28:31]
    v_and_b32 v32, v50, v4
    v_and_b32 v33, v50, v5
    v_and_b32 v34, v50, v6
    v_and_b32 v35, v50, v7
    s_waitcnt vmcnt(4)
    buffer_load_dwordx4 v[124:127], v3, s[40:43], s60 offen nt
    s_add_u32 s60, s60, s61
    v_mfma_f32_16x16x32_bf16 v[28:31], v[104:107], v[32:35], v[28:31]
    v_and_b32 v36, v51, v4
    v_and_b32 v37, v51, v5
    v_and_b32 v38, v51, v6
    v_and_b32 v39, v51, v7
    s_waitcnt vmcnt(4)
    buffer_load_dwordx4 v[128:131], v3, s[40:43], s60 offen nt
    s_add_u32 s60, s60, s61
    v_mfma_f32_16x16x32_bf16 v[28:31], v[108:111], v[36:39], v[28:31]
    v_and_b32 v32, v52, v4
    v_and_b32 v33, v52, v5
    v_and_b32 v34, v52, v6
    v_and_b32 v35, v52, v7
    s_waitcnt vmcnt(4)
    buffer_load_dwordx4 v[132:135], v3, s[40:43], s60 offen nt
    v_mfma_f32_16x16x32_bf16 v[28:31], v[112:115], v[32:35], v[28:31]
    v_and_b32 v36, v53, v4
    v_and_b32 v37, v53, v5
    v_and_b32 v38, v53, v6
    v_and_b32 v39, v53, v7
    s_waitcnt vmcnt(4)
    s_nop 0
    v_mfma_f32_16x16x32_bf16 v[28:31], v[116:119], v[36:39], v[28:31]
    v_and_b32 v32, v54, v4
    v_and_b32 v33, v54, v5
    v_and_b32 v34, v54, v6
    v_and_b32 v35, v54, v7
    s_waitcnt vmcnt(3)
    s_nop 0
    v_mfma_f32_16x16x32_bf16 v[28:31], v[120:123], v[32:35], v[28:31]
    v_and_b32 v36, v55, v4
    v_and_b32 v37, v55, v5
    v_and_b32 v38, v55, v6
    v_and_b32 v39, v55, v7
    s_waitcnt vmcnt(2)
    s_nop 0
    v_mfma_f32_16x16x32_bf16 v[28:31], v[124:127], v[36:39], v[28:31]
    v_and_b32 v32, v56, v4
    v_and_b32 v33, v56, v5
    v_and_b32 v34, v56, v6
    v_and_b32 v35, v56, v7
    s_waitcnt vmcnt(1)
    s_nop 0
    v_mfma_f32_16x16x32_bf16 v[28:31], v[128:131], v[32:35], v[28:31]
    v_and_b32 v36, v57, v4
    v_and_b32 v37, v57, v5
    v_and_b32 v38, v57, v6
    v_and_b32 v39, v57, v7
    s_waitcnt vmcnt(0)
    s_nop 0
    v_mfma_f32_16x16x32_bf16 v[28:31], v[132:135], v[36:39], v[28:31]
    s_branch L_P1d
L_TO:
    v_mul_u32_u24 v1, 9216, v13
    v_lshl_add_u32 v1, v14, 4, v1
    s_mul_i32 s34, s29, 384
    v_add_u32 v1, s34, v1
    s_mov_b32 s46, 4718592
    s_lshr_b32 s67, s28, 2
    s_mul_i32 s64, s67, 73728
    s_add_u32 s65, s64, 4608
    s_waitcnt lgkmcnt(0)
    s_mov_b64 s[44:45], s[12:13]
    s_barrier
    buffer_load_dwordx4 v[64:67], v1, s[44:47], s64 offen offset:0 nt
    buffer_load_dwordx4 v[68:71], v1, s[44:47], s64 offen offset:128 nt
    buffer_load_dwordx4 v[72:75], v1, s[44:47], s64 offen offset:256 nt
    s_mov_b64 s[52:53], s[26:27]
    s_load_dword s32, s[26:27], 0
    s_mov_b32 s96, 100000
    v_and_b32 v10, 1, v0
    v_lshlrev_b32 v10, 4, v10
    v_mov_b32 v12, 0xffff
    v_lshlrev_b32 v10, v10, v12
    v_bfe_u32 v12, v0, 1, 2
    v_cmp_eq_u32 s[68:69], 0, v12
    v_cmp_eq_u32 s[70:71], 1, v12
    v_cmp_eq_u32 s[72:73], 2, v12
    v_cmp_eq_u32 s[74:75], 3, v12
    v_cndmask_b32 v4, 0, v10, s[68:69]
    v_cndmask_b32 v5, 0, v10, s[70:71]
    v_cndmask_b32 v6, 0, v10, s[72:73]
    v_cndmask_b32 v7, 0, v10, s[74:75]
    s_waitcnt vmcnt(2)
    buffer_load_dwordx4 v[76:79], v1, s[44:47], s64 offen offset:1152 nt
    s_waitcnt vmcnt(2)
    buffer_load_dwordx4 v[80:83], v1, s[44:47], s64 offen offset:1280 nt
    s_waitcnt vmcnt(2)
    buffer_load_dwordx4 v[84:87], v1, s[44:47], s64 offen offset:1408 nt
    s_waitcnt vmcnt(2)
    buffer_load_dwordx4 v[88:91], v1, s[44:47], s64 offen offset:2304 nt
    s_waitcnt vmcnt(2)
    buffer_load_dwordx4 v[92:95], v1, s[44:47], s64 offen offset:2432 nt
    s_waitcnt vmcnt(2)
    buffer_load_dwordx4 v[96:99], v1, s[44:47], s64 offen offset:2560 nt
    s_waitcnt vmcnt(2)
    buffer_load_dwordx4 v[100:103], v1, s[44:47], s64 offen offset:3456 nt
    s_waitcnt vmcnt(2)
    buffer_load_dwordx4 v[104:107], v1, s[44:47], s64 offen offset:3584 nt
    s_waitcnt vmcnt(2)
    buffer_load_dwordx4 v[108:111], v1, s[44:47], s64 offen offset:3712 nt
    s_waitcnt vmcnt(2)
    buffer_load_dwordx4 v[112:115], v1, s[44:47], s65 offen offset:0 nt
    s_waitcnt vmcnt(2)
    buffer_load_dwordx4 v[116:119], v1, s[44:47], s65 offen offset:128 nt
    s_waitcnt vmcnt(2)
    buffer_load_dwordx4 v[120:123], v1, s[44:47], s65 offen offset:256 nt
    s_waitcnt vmcnt(2)
    buffer_load_dwordx4 v[124:127], v1, s[44:47], s65 offen offset:1152 nt
    s_waitcnt vmcnt(2)
    buffer_load_dwordx4 v[128:131], v1, s[44:47], s65 offen offset:1280 nt
    s_waitcnt vmcnt(2)
    buffer_load_dwordx4 v[132:135], v1, s[44:47], s65 offen offset:1408 nt
    s_waitcnt vmcnt(2)
    buffer_load_dwordx4 v[136:139], v1, s[44:47], s65 offen offset:2304 nt
    s_waitcnt vmcnt(2)
    buffer_load_dwordx4 v[140:143], v1, s[44:47], s65 offen offset:2432 nt
    s_waitcnt vmcnt(2)
    buffer_load_dwordx4 v[144:147], v1, s[44:47], s65 offen offset:2560 nt
    s_waitcnt vmcnt(2)
    buffer_load_dwordx4 v[148:151], v1, s[44:47], s65 offen offset:3456 nt
    s_waitcnt vmcnt(2)
    buffer_load_dwordx4 v[152:155], v1, s[44:47], s65 offen offset:3584 nt
    s_waitcnt vmcnt(2)
    buffer_load_dwordx4 v[156:159], v1, s[44:47], s65 offen offset:3712 nt
    s_waitcnt lgkmcnt(0)
    s_add_u32 s32, s32, 0x9e3779b9
    v_mov_b32 v15, 0
    s_mov_b32 s97, 800000
L_fwo:
    ds_read_b32 v16, v15 offset:2816
    s_waitcnt lgkmcnt(0)
    v_readfirstlane_b32 s98, v16
    s_cmp_lg_u32 s98, 0
    s_cbranch_scc1 L_fwo_g
    s_sleep 4
    s_sub_u32 s97, s97, 1
    s_cbranch_scc0 L_fwo
L_fwo_g:
    s_and_b32 s98, s98, 4194304
    s_branch L_Tcommon
L_TF:
    v_mov_b32 v15, 0
    s_mov_b32 s97, 800000
L_fwf:
    ds_read_b32 v16, v15 offset:2816
    s_waitcnt lgkmcnt(0)
    v_readfirstlane_b32 s98, v16
    s_cmp_lg_u32 s98, 0
    s_cbranch_scc1 L_fwf_g
    s_sleep 4
    s_sub_u32 s97, s97, 1
    s_cbranch_scc0 L_fwf
L_fwf_g:
    s_and_b32 s98, s98, 4194304
    s_cbranch_scc0 L_TF1
    s_mov_b32 exec_lo, s34
    s_mov_b32 exec_hi, s34
    buffer_store_dwordx4 v[8:11], v12, s[52:55], s66 offen sc1
    s_mov_b64 exec, -1
L_TF1:
    s_mov_b64 s[44:45], s[20:21]
    s_mov_b32 s46, 5308416
    s_lshr_b32 s67, s28, 2
    s_mul_i32 s67, s67, 3
    s_add_u32 s67, s67, s31
    s_sub_u32 s67, s67, 1
    s_mul_i32 s64, s67, 27648
    s_add_u32 s65, s64, 9216
    s_add_u32 s66, s64, 18432
    s_add_u32 s67, s67, 64
    v_mul_u32_u24 v1, 1152, v13
    v_lshl_add_u32 v1, v14, 4, v1
    s_mul_i32 s34, s29, 384
    v_add_u32 v1, s34, v1
L_Tcommon:
    v_lshlrev_b32 v61, 5, v13
    s_lshl_b32 s60, s29, 6
    v_add_u32 v59, s60, v0
    v_lshrrev_b32 v59, 3, v59
    v_lshlrev_b32 v59, 15, v59
    v_lshl_or_b32 v59, v14, 4, v59
    s_sub_u32 s74, s67, 64
    s_mul_i32 s67, s67, 128
    s_add_u32 s67, s67, 2097152
    v_mov_b32 v2, s60
    s_lshl_b32 s60, s29, 9
    v_lshl_add_u32 v58, v0, 3, s60
    v_lshrrev_b32 v3, 5, v0
    v_and_b32 v9, 31, v0
    v_lshlrev_b32 v9, 4, v9
    v_lshl_or_b32 v3, v3, 13, v9
    s_lshr_b32 s60, s28, 4
    s_lshl_b32 s60, s60, 15
    s_lshl_b32 s61, s29, 14
    s_add_u32 s60, s60, s61
    s_and_b32 s61, s28, 15
    s_lshl_b32 s61, s61, 9
    s_add_u32 s60, s60, s61
    s_add_u32 s60, s60, 524288
    s_or_b32 s61, s60, 4194304
    v_and_b32 v9, 1, v0
    v_cmp_eq_u32 s[62:63], 1, v9
    s_mov_b32 s35, 0x3fb8aa3b
    v_mov_b32 v11, s32
    s_cmp_eq_u32 s29, 2
    s_cbranch_scc1 L_mlx
    s_mov_b32 s97, 800000
L_mlw:
    ds_read_b128 v[16:19], v2 offset:11264
    ds_read_b128 v[20:23], v2 offset:11280
    ds_read_b128 v[24:27], v2 offset:11296
    ds_read_b128 v[28:31], v2 offset:11312
    s_waitcnt lgkmcnt(0)
    v_min3_u32 v10, v17, v19, v21
    v_min3_u32 v12, v23, v25, v27
    v_min3_u32 v10, v10, v29, v31
    v_min_u32 v10, v10, v12
    v_cmp_eq_u32 vcc, 0, v10
    s_cbranch_vccz L_mlg
    s_sleep 3
    s_sub_u32 s97, s97, 1
    s_cbranch_scc0 L_mlw
L_mlg:
    ds_read_b128 v[16:19], v2 offset:11264
    ds_read_b128 v[20:23], v2 offset:11280
    ds_read_b128 v[24:27], v2 offset:11296
    ds_read_b128 v[28:31], v2 offset:11312
    s_waitcnt lgkmcnt(0)
    v_max3_f32 v10, v16, v18, v20
    v_max3_f32 v12, v22, v24, v26
    v_max3_f32 v10, v10, v28, v30
    v_max_f32 v10, v10, v12
    v_sub_f32 v16, v16, v10
    v_sub_f32 v18, v18, v10
    v_sub_f32 v20, v20, v10
    v_sub_f32 v22, v22, v10
    v_sub_f32 v24, v24, v10
    v_sub_f32 v26, v26, v10
    v_sub_f32 v28, v28, v10
    v_sub_f32 v30, v30, v10
    v_exp_f32 v16, v16
    v_exp_f32 v18, v18
    v_exp_f32 v20, v20
    v_exp_f32 v22, v22
    v_exp_f32 v24, v24
    v_exp_f32 v26, v26
    v_exp_f32 v28, v28
    v_exp_f32 v30, v30
    v_mul_f32 v12, v16, v17
    v_fmac_f32 v12, v18, v19
    v_fmac_f32 v12, v20, v21
    v_fmac_f32 v12, v22, v23
    v_fmac_f32 v12, v24, v25
    v_fmac_f32 v12, v26, v27
    v_fmac_f32 v12, v28, v29
    v_fmac_f32 v12, v30, v31
    v_cndmask_b32 v10, v10, v12, s[62:63]
    s_cmp_eq_u32 s29, 2
L_mlx:
    s_waitcnt vmcnt(2)
    s_barrier
    s_cbranch_scc1 L_nocomb
    ds_read_b64 v[32:33], v58 offset:3072
    ds_read_b64 v[34:35], v58 offset:4096
    ds_read_b64 v[36:37], v58 offset:5120
    ds_read_b64 v[38:39], v58 offset:6144
    ds_read_b64 v[40:41], v58 offset:7168
    ds_read_b64 v[42:43], v58 offset:8192
    ds_read_b64 v[44:45], v58 offset:9216
    ds_read_b64 v[46:47], v58 offset:10240
    s_waitcnt lgkmcnt(6)
    v_pk_mul_f32 v[8:9], v[32:33], v[16:17] op_sel_hi:[1,0]
    v_pk_fma_f32 v[8:9], v[34:35], v[18:19], v[8:9] op_sel_hi:[1,0,1]
    s_waitcnt lgkmcnt(4)
    v_pk_fma_f32 v[8:9], v[36:37], v[20:21], v[8:9] op_sel_hi:[1,0,1]
    v_pk_fma_f32 v[8:9], v[38:39], v[22:23], v[8:9] op_sel_hi:[1,0,1]
    s_waitcnt lgkmcnt(2)
    v_pk_fma_f32 v[8:9], v[40:41], v[24:25], v[8:9] op_sel_hi:[1,0,1]
    v_pk_fma_f32 v[8:9], v[42:43], v[26:27], v[8:9] op_sel_hi:[1,0,1]
    s_waitcnt lgkmcnt(0)
    v_pk_fma_f32 v[8:9], v[44:45], v[28:29], v[8:9] op_sel_hi:[1,0,1]
    v_pk_fma_f32 v[8:9], v[46:47], v[30:31], v[8:9] op_sel_hi:[1,0,1]
    buffer_store_dwordx4 v[8:11], v3, s[52:55], s61 offen
    s_cmp_eq_u32 s98, 0
    s_cbranch_scc1 L_no2B
    buffer_store_dwordx4 v[8:11], v3, s[52:55], s60 offen sc1
L_no2B:
L_nocomb:
    s_barrier
    s_cmp_eq_u32 s31, 0
    s_cbranch_scc1 L_TO2
    buffer_load_dwordx4 v[124:127], v1, s[44:47], s64 offen offset:0 nt
    buffer_load_dwordx4 v[128:131], v1, s[44:47], s64 offen offset:128 nt
    buffer_load_dwordx4 v[132:135], v1, s[44:47], s64 offen offset:256 nt
    buffer_load_dwordx4 v[136:139], v1, s[44:47], s65 offen offset:0 nt
    buffer_load_dwordx4 v[140:143], v1, s[44:47], s65 offen offset:128 nt
    buffer_load_dwordx4 v[144:147], v1, s[44:47], s65 offen offset:256 nt
    buffer_load_dwordx4 v[148:151], v1, s[44:47], s66 offen offset:0 nt
    buffer_load_dwordx4 v[152:155], v1, s[44:47], s66 offen offset:128 nt
    buffer_load_dwordx4 v[156:159], v1, s[44:47], s66 offen offset:256 nt
    ds_read_b128 v[20:23], v61 offset:11408
    v_mov_b32 v36, 0
    v_mov_b32 v37, 0
    v_mov_b32 v38, 0
    v_mov_b32 v39, 0
    v_mov_b32 v40, 0
    v_mov_b32 v41, 0
    v_mov_b32 v42, 0
    v_mov_b32 v43, 0
    v_mov_b32 v44, 0
    v_mov_b32 v45, 0
    v_mov_b32 v46, 0
    v_mov_b32 v47, 0
    s_waitcnt lgkmcnt(0)
    v_and_b32 v52, v21, v4
    v_and_b32 v53, v21, v5
    v_and_b32 v54, v21, v6
    v_and_b32 v55, v21, v7
    s_nop 0
    s_branch L_tail5
L_TO2:
    v_mov_b32 v36, 0
    v_mov_b32 v37, 0
    v_mov_b32 v38, 0
    v_mov_b32 v39, 0
    v_mov_b32 v40, 0
    v_mov_b32 v41, 0
    v_mov_b32 v42, 0
    v_mov_b32 v43, 0
    v_mov_b32 v44, 0
    v_mov_b32 v45, 0
    v_mov_b32 v46, 0
    v_mov_b32 v47, 0
    s_barrier
    ds_read_b128 v[16:19], v61 offset:11392
    ds_read_b128 v[20:23], v61 offset:11408
    s_waitcnt lgkmcnt(0)
    v_and_b32 v48, v16, v4
    v_and_b32 v49, v16, v5
    v_and_b32 v50, v16, v6
    v_and_b32 v51, v16, v7
    s_nop 1
    v_mfma_f32_16x16x32_bf16 v[36:39], v[64:67], v[48:51], v[36:39]
    v_and_b32 v52, v17, v4
    v_and_b32 v53, v17, v5
    v_mfma_f32_16x16x32_bf16 v[40:43], v[68:71], v[48:51], v[40:43]
    v_and_b32 v54, v17, v6
    v_and_b32 v55, v17, v7
    v_mfma_f32_16x16x32_bf16 v[44:47], v[72:75], v[48:51], v[44:47]
    s_nop 0
    v_mfma_f32_16x16x32_bf16 v[36:39], v[76:79], v[52:55], v[36:39]
    v_and_b32 v48, v18, v4
    v_and_b32 v49, v18, v5
    v_mfma_f32_16x16x32_bf16 v[40:43], v[80:83], v[52:55], v[40:43]
    v_and_b32 v50, v18, v6
    v_and_b32 v51, v18, v7
    v_mfma_f32_16x16x32_bf16 v[44:47], v[84:87], v[52:55], v[44:47]
    s_nop 0
    v_mfma_f32_16x16x32_bf16 v[36:39], v[88:91], v[48:51], v[36:39]
    v_and_b32 v52, v19, v4
    v_and_b32 v53, v19, v5
    v_mfma_f32_16x16x32_bf16 v[40:43], v[92:95], v[48:51], v[40:43]
    v_and_b32 v54, v19, v6
    v_and_b32 v55, v19, v7
    v_mfma_f32_16x16x32_bf16 v[44:47], v[96:99], v[48:51], v[44:47]
    s_nop 0
    v_mfma_f32_16x16x32_bf16 v[36:39], v[100:103], v[52:55], v[36:39]
    v_and_b32 v48, v20, v4
    v_and_b32 v49, v20, v5
    v_mfma_f32_16x16x32_bf16 v[40:43], v[104:107], v[52:55], v[40:43]
    v_and_b32 v50, v20, v6
    v_and_b32 v51, v20, v7
    v_mfma_f32_16x16x32_bf16 v[44:47], v[108:111], v[52:55], v[44:47]
    s_nop 0
    v_mfma_f32_16x16x32_bf16 v[36:39], v[112:115], v[48:51], v[36:39]
    v_and_b32 v52, v21, v4
    v_and_b32 v53, v21, v5
    v_mfma_f32_16x16x32_bf16 v[40:43], v[116:119], v[48:51], v[40:43]
    v_and_b32 v54, v21, v6
    v_and_b32 v55, v21, v7
    v_mfma_f32_16x16x32_bf16 v[44:47], v[120:123], v[48:51], v[44:47]
L_tail5:
    s_waitcnt vmcnt(8)
    v_mfma_f32_16x16x32_bf16 v[36:39], v[124:127], v[52:55], v[36:39]
    v_and_b32 v48, v22, v4
    v_and_b32 v49, v22, v5
    s_waitcnt vmcnt(7)
    v_mfma_f32_16x16x32_bf16 v[40:43], v[128:131], v[52:55], v[40:43]
    v_and_b32 v50, v22, v6
    v_and_b32 v51, v22, v7
    s_waitcnt vmcnt(6)
    v_mfma_f32_16x16x32_bf16 v[44:47], v[132:135], v[52:55], v[44:47]
    s_waitcnt vmcnt(5)
    v_mfma_f32_16x16x32_bf16 v[36:39], v[136:139], v[48:51], v[36:39]
    v_and_b32 v52, v23, v4
    v_and_b32 v53, v23, v5
    s_waitcnt vmcnt(4)
    v_mfma_f32_16x16x32_bf16 v[40:43], v[140:143], v[48:51], v[40:43]
    v_and_b32 v54, v23, v6
    v_and_b32 v55, v23, v7
    s_waitcnt vmcnt(3)
    v_mfma_f32_16x16x32_bf16 v[44:47], v[144:147], v[48:51], v[44:47]
    s_waitcnt vmcnt(2)
    v_mfma_f32_16x16x32_bf16 v[36:39], v[148:151], v[52:55], v[36:39]
    s_waitcnt vmcnt(1)
    v_mfma_f32_16x16x32_bf16 v[40:43], v[152:155], v[52:55], v[40:43]
    s_waitcnt vmcnt(0)
    v_mfma_f32_16x16x32_bf16 v[44:47], v[156:159], v[52:55], v[44:47]
    s_nop 3
    v_permlane32_swap_b32 v36, v37
    v_permlane32_swap_b32 v38, v39
    v_permlane32_swap_b32 v40, v41
    v_permlane32_swap_b32 v42, v43
    v_permlane32_swap_b32 v44, v45
    v_permlane32_swap_b32 v46, v47
    v_add_f32_dpp v8, v37, v36 row_ror:8 row_mask:0xf bank_mask:0x3
    v_add_f32_dpp v9, v41, v40 row_ror:8 row_mask:0xf bank_mask:0x3
    v_add_f32_dpp v10, v45, v44 row_ror:8 row_mask:0xf bank_mask:0x3
    v_add_f32_dpp v8, v38, v39 row_ror:8 row_mask:0xf bank_mask:0xc
    v_add_f32_dpp v9, v42, v43 row_ror:8 row_mask:0xf bank_mask:0xc
    v_add_f32_dpp v10, v46, v47 row_ror:8 row_mask:0xf bank_mask:0xc
    buffer_store_dwordx4 v[8:11], v59, s[52:55], s67 offen sc1
L_np3:
    s_cmp_eq_u32 s31, 0
    s_cbranch_scc1 L_Tend
    s_and_b32 s34, s74, 7
    s_cbranch_scc1 L_Tend
    s_barrier
    s_lshl_b32 s72, s74, 12
    s_lshl_b32 s34, s3, 13
    s_add_u32 s72, s72, s34
    s_add_u32 s72, s72, 2097152
    s_add_u32 s73, s72, 4096
    v_lshlrev_b32 v2, 4, v0
    s_lshl_b32 s34, s29, 8
    v_lshl_add_u32 v3, v0, 2, s34
    v_mov_b32 v60, -1
    s_lshl_b32 s34, s29, 2
    v_mov_b32 v61, s34
L_poll3f:
    buffer_load_dwordx4 v[16:19], v2, s[52:55], s72 offen offset:0 sc1
    buffer_load_dwordx4 v[20:23], v2, s[52:55], s72 offen offset:1024 sc1
    buffer_load_dwordx4 v[24:27], v2, s[52:55], s72 offen offset:2048 sc1
    buffer_load_dwordx4 v[28:31], v2, s[52:55], s72 offen offset:3072 sc1
    buffer_load_dwordx4 v[32:35], v2, s[52:55], s73 offen offset:0 sc1
    buffer_load_dwordx4 v[36:39], v2, s[52:55], s73 offen offset:1024 sc1
    buffer_load_dwordx4 v[40:43], v2, s[52:55], s73 offen offset:2048 sc1
    buffer_load_dwordx4 v[44:47], v2, s[52:55], s73 offen offset:3072 sc1
    s_waitcnt vmcnt(6)
    v_xor_b32 v12, s32, v19
    v_pk_add_f32 v[56:57], v[16:17], v[20:21]
    v_add_f32 v58, v18, v22
    v_bitop3_b32 v12, v23, s32, v12 bitop3:0xbe
    s_waitcnt vmcnt(5)
    v_pk_add_f32 v[56:57], v[56:57], v[24:25]
    v_add_f32 v58, v58, v26
    v_bitop3_b32 v12, v27, s32, v12 bitop3:0xbe
    s_waitcnt vmcnt(4)
    v_pk_add_f32 v[56:57], v[56:57], v[28:29]
    v_add_f32 v58, v58, v30
    v_bitop3_b32 v12, v31, s32, v12 bitop3:0xbe
    s_waitcnt vmcnt(3)
    v_pk_add_f32 v[56:57], v[56:57], v[32:33]
    v_add_f32 v58, v58, v34
    v_bitop3_b32 v12, v35, s32, v12 bitop3:0xbe
    s_waitcnt vmcnt(2)
    v_pk_add_f32 v[56:57], v[56:57], v[36:37]
    v_add_f32 v58, v58, v38
    v_bitop3_b32 v12, v39, s32, v12 bitop3:0xbe
    s_waitcnt vmcnt(1)
    v_pk_add_f32 v[56:57], v[56:57], v[40:41]
    v_add_f32 v58, v58, v42
    v_bitop3_b32 v12, v43, s32, v12 bitop3:0xbe
    s_waitcnt vmcnt(0)
    v_pk_add_f32 v[56:57], v[56:57], v[44:45]
    v_add_f32 v58, v58, v46
    v_bitop3_b32 v12, v47, s32, v12 bitop3:0xbe
    v_cmp_ne_u32 vcc, 0, v12
    s_cbranch_vccz L_poll3f_g
    s_sleep 2
    s_sub_u32 s96, s96, 1
    s_cbranch_scc0 L_poll3f
L_poll3f_g:
    v_permlane32_swap_b32 v56, v58
    v_permlane32_swap_b32 v57, v59
    v_add_f32 v56, v56, v58
    v_add_f32 v57, v57, v59
    s_nop 1
    v_permlane16_swap_b32 v56, v57
    v_add_f32 v56, v56, v57
    s_nop 1
    v_add_f32_dpp v56, v56, v56 row_ror:8 row_mask:0xf bank_mask:0xf
    ds_write_b32 v3, v56 offset:0
    ds_write_b32 v61, v60 offset:2832
    s_or_b32 s34, s74, s29
    s_waitcnt lgkmcnt(0)
    s_barrier
    s_cbranch_scc1 L_Tend
    s_mov_b64 exec, 1
    buffer_store_dword v11, v2, s[52:55], 0 offen
L_Tend:
    s_waitcnt vmcnt(0)
    s_endpgm
L_exit:
    s_endpgm
.section .rodata,"a"
.p2align 6
.amdhsa_kernel recurrent_scan__gqa_block_cached__swiglu_ffn__decode_kernel
  .amdhsa_next_free_vgpr 168
  .amdhsa_next_free_sgpr 102
  .amdhsa_accum_offset 168
  .amdhsa_group_segment_fixed_size 0
  .amdhsa_kernarg_size 96
  .amdhsa_user_sgpr_count 2
  .amdhsa_user_sgpr_kernarg_segment_ptr 1
  .amdhsa_system_sgpr_workgroup_id_x 1
  .amdhsa_float_denorm_mode_32 3
  .amdhsa_float_denorm_mode_16_64 3
.end_amdhsa_kernel
```
